```python
import torch

def _softmax(x, axis=-1):
    return torch.softmax(x, dim=axis)
def _gelu(x):
    return torch.nn.functional.gelu(x, approximate="tanh")
def _silu(x):
    return torch.nn.functional.silu(x)
def _sigmoid(x):
    return torch.sigmoid(x)
def _layernorm(x, axis=-1, eps=1e-5):
    m = x.mean(dim=axis, keepdim=True)
    v = x.var(dim=axis, keepdim=True, unbiased=False)
    return (x - m) / torch.sqrt(v + eps)
def _scatter_add(tgt, idx, src, axis=0):
    return tgt.clone().index_add_(axis, idx, src)
def _segment_sum(src, seg, n):
    out = torch.zeros((n,) + src.shape[1:], dtype=src.dtype)
    return out.index_add_(0, seg, src)
def _pad(x, pw):
    flat = tuple(v for pair in reversed(pw) for v in pair)
    return torch.nn.functional.pad(x, flat)

kernel_name = 'sequential_preLN__sliding_block_cached__glu_gated_glu__decode'

def setup_inputs():

    _w = (lambda a: (lambda t: t.to(torch.bfloat16) if t.is_floating_point() else t)(torch.as_tensor(a)))
    def _A_setup():
        B, Sq, D = 8, 1, 640
        Hq, Hkv, Sk, Dh = 32, 32, 4096, 128
        assert Hq % Hkv == 0, (Hq, Hkv)
        return {
            "x": _w((lambda *s: torch.randn(*s, dtype=torch.bfloat16) * 0.05)(B, Sq, D)),
            "k_cache": _w((lambda *s: torch.randn(*s, dtype=torch.bfloat16) * 3.2)(B, Hkv, Sk, Dh)),
            "v_cache": _w((lambda *s: torch.randn(*s, dtype=torch.bfloat16) * 0.4)(B, Hkv, Sk, Dh)),
            "wq": _w((lambda *s: torch.randn(*s, dtype=torch.bfloat16) * 3.2)(D, Hq * Dh) * (D ** -0.5)),
            "wo": _w((lambda *s: torch.randn(*s, dtype=torch.bfloat16) * 0.4)(Hq * Dh, D) * ((Hq * Dh) ** -0.5)),
        }
    _A_in = _A_setup()

    def _B_setup():
        B, S, D, F = 8, 1, 640, 1728
        return {
            "x": _w((lambda *s: torch.randn(*s, dtype=torch.bfloat16) * 0.05)(B, S, D)),
            "w_gate": _w((lambda *s: torch.randn(*s, dtype=torch.bfloat16) * 0.1)(D, F)),
            "w_up": _w((lambda *s: torch.randn(*s, dtype=torch.bfloat16) * 0.05)(D, F)),
            "w_down": _w((lambda *s: torch.randn(*s, dtype=torch.bfloat16) * 0.05)(F, D)),
        }
    _B_in = _B_setup()

    return {
        "A_x": _A_in["x"],
        "A_k_cache": _A_in["k_cache"],
        "A_v_cache": _A_in["v_cache"],
        "A_wq": _A_in["wq"],
        "A_wo": _A_in["wo"],
        "B_x": _B_in["x"],
        "B_w_gate": _B_in["w_gate"],
        "B_w_up": _B_in["w_up"],
        "B_w_down": _B_in["w_down"],
    }

def reference(A_x, A_k_cache, A_v_cache, A_wq, A_wo, B_x, B_w_gate, B_w_up, B_w_down):
    def _A_ref(x, k_cache, v_cache, wq, wo):
        B, Sq, D = x.shape
        Hq, Dh = 32, 128
        Hkv, Sk = k_cache.shape[1], k_cache.shape[2]
        W = min(4096, max(256, Sk // 4))
        rep = Hq // Hkv
        q = (lambda x, *d: x.permute(*d))((x @ wq).reshape(B, Sq, Hq, Dh), 0, 2, 1, 3)
        k = (lambda x, n, axis: torch.repeat_interleave(x, n, dim=axis))(k_cache[:, :, Sk - W:, :], rep, axis=1)
        v = (lambda x, n, axis: torch.repeat_interleave(x, n, dim=axis))(v_cache[:, :, Sk - W:, :], rep, axis=1)
        scores = torch.einsum("bhqd,bhkd->bhqk", q, k) * (Dh ** -0.5)
        p = _softmax(scores, axis=-1)
        o = torch.einsum("bhqk,bhkd->bhqd", p, v)
        return (lambda x, *d: x.permute(*d))(o, 0, 2, 1, 3).reshape(B, Sq, Hq * Dh) @ wo

    def _B_ref(x, w_gate, w_up, w_down):
        g = torch.einsum("bsd,df->bsf", x, w_gate)
        u = torch.einsum("bsd,df->bsf", x, w_up)
        h = _sigmoid(g) * u
        return torch.einsum("bsf,fd->bsd", h, w_down)

    x = A_x
    h = x + _A_ref(_layernorm(x, axis=-1), A_k_cache, A_v_cache, A_wq, A_wo)
    h2 = h + _B_ref(_layernorm(h, axis=-1), B_w_gate, B_w_up, B_w_down)
    return h2
```

```asm
; @launch grid=(256,1,1) block=(256,1,1) lds=134400
.amdgcn_target "amdgcn-amd-amdhsa--gfx950"
.text
.globl sequential_preLN__sliding_block_cached__glu_gated_glu__decode_kernel
.p2align 8
.type sequential_preLN__sliding_block_cached__glu_gated_glu__decode_kernel,@function
sequential_preLN__sliding_block_cached__glu_gated_glu__decode_kernel:
    s_load_dwordx4 s[8:11], s[0:1], 0
    s_load_dwordx4 s[12:15], s[0:1], 16
    s_load_dwordx16 s[16:31], s[0:1], 32
    s_cmp_ge_u32 s2, 256
    s_cbranch_scc1 L_end
    v_lshlrev_b32 v2, 4, v0
    s_lshl_b32 s7, s2, 20
    s_add_u32 s7, s7, 0xC0000
    v_readfirstlane_b32 s3, v0
    s_mov_b32 s34, 0x40000
    s_mov_b32 s35, 0x20000
    s_lshr_b32 s59, s2, 3
    s_mul_i32 s97, s59, 8192
    s_and_b32 s97, s97, 0x3f000
    s_lshr_b32 s3, s3, 6
    s_or_b32 s59, s59, s3
    s_cbranch_scc0 L_lead
    s_waitcnt lgkmcnt(0)
L_k0:
    s_add_u32 s32, s10, s7
    s_addc_u32 s33, s11, 0
    s_xor_b32 s6, s97, 0
    buffer_load_dwordx4 v[96:99], v2, s[32:35], s6 offen nt
    s_xor_b32 s6, s97, 4096
    buffer_load_dwordx4 v[100:103], v2, s[32:35], s6 offen nt
    s_xor_b32 s6, s97, 8192
    buffer_load_dwordx4 v[104:107], v2, s[32:35], s6 offen nt
    s_xor_b32 s6, s97, 12288
    buffer_load_dwordx4 v[108:111], v2, s[32:35], s6 offen nt
    v_and_b32 v1, 63, v0
    s_and_b32 s99, s2, 7
    s_mul_i32 s58, s99, 5632
    s_add_u32 s58, s58, 615424
    v_lshl_add_u32 v89, v1, 2, s58
    v_lshrrev_b32 v52, 5, v0
    v_and_b32 v53, 31, v0
    v_mul_u32_u24 v37, 1280, v52
    v_lshl_add_u32 v37, v53, 3, v37
    v_mul_u32_u24 v91, 1312, v52
    v_lshl_add_u32 v91, v53, 3, v91
    s_mov_b32 s38, 0x40000
    s_mov_b32 s39, 0x20000
    s_add_u32 s36, s12, s7
    s_addc_u32 s37, s13, 0
    s_lshr_b32 s4, s2, 5
    s_and_b32 s5, s2, 31
    s_lshr_b32 s56, s4, 1
    s_and_b32 s57, s4, 1
    s_mul_i32 s58, s56, 160
    s_mul_i32 s59, s3, 40
    s_add_u32 s58, s58, s59
    v_lshrrev_b32 v52, 3, v1
    v_add_u32 v52, s58, v52
    v_lshlrev_b32 v52, 13, v52
    v_and_b32 v53, 7, v1
    v_lshl_add_u32 v52, v53, 4, v52
    s_lshl_b32 s58, s5, 8
    s_lshl_b32 s59, s57, 7
    s_add_u32 s58, s58, s59
    v_add_u32 v36, s58, v52
    s_mul_i32 s7, s3, 5120
    s_add_u32 s7, s7, 16384
    s_mov_b32 s42, 5242880
    s_mov_b32 s43, 0x20000
    s_mov_b32 s40, s14
    s_mov_b32 s41, s15
    s_sub_u32 s58, 8, s99
    s_and_b32 s58, s58, 7
    s_mul_i32 s58, s58, 12
    s_lshr_b32 s57, s5, 3
    s_mul_i32 s59, s57, 3
    s_add_u32 s58, s58, s59
    s_add_u32 s58, s58, s4
    s_sub_u32 s58, s58, 5
    s_sub_u32 s59, s58, 40
    s_cmp_lt_u32 s58, 40
    s_cselect_b32 s60, 2, 1
    s_cselect_b32 s61, s58, s59
    s_cmp_ge_u32 s58, 94
    s_cselect_b32 s60, 3, s60
    s_and_b32 s58, s57, 1
    s_lshl_b32 s59, s4, 1
    s_add_u32 s59, s59, s58
    s_cmp_lt_u32 s4, 5
    s_cselect_b32 s60, 0, s60
    s_cselect_b32 s61, s59, s61
    s_mov_b32 vcc_lo, 353435904
    s_mov_b32 vcc_hi, 2138527573
    s_mov_b32 s1, 13
    s_mov_b32 s12, 0
    s_cmp_eq_u32 s60, 1
    s_cselect_b32 s1, 15, s1
    s_cselect_b32 s12, 140, s12
    s_cmp_eq_u32 s60, 0
    s_cselect_b32 s1, 13, s1
    s_cselect_b32 s12, 0, s12
    s_cmp_lt_u32 s2, 8
    s_cselect_b32 s13, 15, s1
    s_lshr_b32 s0, s2, 3
    s_add_u32 s0, s0, s3
    s_and_b32 s0, s0, 7
    s_mov_b32 s15, 0
    s_and_b32 s58, s13, 7
    s_lshl_b32 s58, s58, 3
    s_lshr_b64 s[58:59], vcc, s58
    s_and_b32 s58, s58, 0xff
    s_mul_i32 s58, s58, 0x01010101
    s_mov_b32 s59, s58
    s_lshr_b64 s[58:59], s[58:59], s0
    s_cmp_ge_u32 s13, 8
    s_cselect_b32 s52, -1, s58
    s_cselect_b32 s53, s58, 0
    s_cmp_ge_u32 s13, 16
    s_cselect_b32 s53, -1, s53
    s_cselect_b32 s54, s58, 0
    s_cmp_ge_u32 s13, 24
    s_cselect_b32 s54, -1, s54
    s_lshr_b32 s57, s5, 3
    s_and_b32 s58, s57, 1
    s_lshr_b32 s55, s57, 1
    s_lshl_b32 s59, s99, 1
    s_add_u32 s55, s55, s59
    s_lshl_b32 s58, s58, 7
    s_and_b32 s59, s4, 1
    s_lshl_b32 s59, s59, 6
    s_add_u32 s58, s58, s59
    s_lshl_b32 s59, s56, 4
    s_add_u32 s58, s58, s59
    s_lshl_b32 s59, s55, 12
    s_add_u32 s58, s58, s59
    s_add_u32 s58, s58, 524288
    v_and_b32 v52, 3, v1
    v_lshl_add_u32 v93, v52, 2, s58
    v_lshrrev_b32 v52, 2, v1
    v_lshl_add_u32 v93, v52, 8, v93
    s_mov_b32 s47, 0x20000
    s_mov_b64 s[48:49], 0
    s_mov_b32 s63, 0
    s_mov_b32 s64, 0
    s_mul_i32 s65, s3, 21760
    s_add_u32 s65, s65, 36864
    s_mov_b32 s51, s65
    s_cmp_eq_u32 s60, 1
    s_cbranch_scc1 L_rf2
    s_cmp_eq_u32 s60, 0
    s_cbranch_scc1 L_rw1
    s_mov_b32 s44, s24
    s_mov_b32 s45, s25
    s_cmp_eq_u32 s60, 2
    s_cselect_b32 s46, 2211840, 0
    s_cselect_b32 s50, 0, 0
    s_mov_b32 s62, 40960
    s_and_b32 s64, s61, 3
    s_lshl_b32 s64, s64, 1
    s_min_u32 s64, s64, 5
    s_mul_i32 s64, s64, 81920
    s_mul_i32 s58, s3, 448
    v_lshrrev_b32 v86, 1, v1
    v_add_u32 v86, s58, v86
    v_mul_u32_u24 v86, 1280, v86
    v_and_b32 v87, 1, v1
    v_lshl_add_u32 v86, v87, 4, v86
    s_lshl_b32 s58, s61, 5
    v_add_u32 v3, s58, v86
    s_branch L_rj3
L_rf2:
    s_mov_b32 s44, s20
    s_mov_b32 s45, s21
    s_mov_b32 s46, 2211840
    s_xor_b64 s[48:49], s[20:21], s[22:23]
    s_mov_b32 s50, 0
    s_bitcmp1_b32 s61, 0
    s_cselect_b32 s64, 497664, 0
    s_mov_b32 s62, 0
    s_mov_b32 s63, 55296
    s_cselect_b32 s63, -55296, s63
    s_mul_i32 s58, s3, 160
    v_lshrrev_b32 v86, 2, v1
    v_add_u32 v86, s58, v86
    v_mul_u32_u24 v86, 3456, v86
    v_lshrrev_b32 v87, 4, v1
    v_and_b32 v87, 2, v87
    v_xor_b32 v87, v87, v1
    v_and_b32 v87, 3, v87
    v_lshl_add_u32 v86, v87, 4, v86
    s_lshl_b32 s58, s61, 6
    v_add_u32 v3, s58, v86
    s_branch L_rj3
L_rw1:
    s_mov_b32 s44, s16
    s_mov_b32 s45, s17
    s_mov_b32 s46, 5242880
    s_mov_b32 s50, 31
    s_mov_b32 s62, 10240
    s_and_b32 s58, s5, 0x17
    s_lshr_b32 s59, s3, 1
    s_lshl_b32 s59, s59, 3
    s_add_u32 s58, s58, s59
    s_lshl_b32 s58, s58, 7
    s_and_b32 s59, s3, 1
    s_lshl_b32 s59, s59, 6
    s_add_u32 s58, s58, s59
    v_lshrrev_b32 v87, 3, v1
    v_add_u32 v86, s58, v87
    v_mul_u32_u24 v86, 1280, v86
    v_and_b32 v87, 2, v87
    v_xor_b32 v87, v87, v1
    v_and_b32 v87, 7, v87
    v_lshl_add_u32 v86, v87, 4, v86
    s_lshl_b32 s58, s61, 7
    v_add_u32 v3, s58, v86
L_rj3:
    s_xor_b32 s6, s97, 16384
    buffer_load_dwordx4 v[112:115], v2, s[32:35], s6 offen nt
    s_add_u32 m0, s7, 0
    s_mov_b32 s58, 0
    buffer_load_dwordx4 v36, s[40:43], s58 offen nt lds
    s_add_u32 m0, s7, 1024
    s_mov_b32 s58, 65536
    buffer_load_dwordx4 v36, s[40:43], s58 offen nt lds
    s_add_u32 m0, s7, 2048
    s_mov_b32 s58, 131072
    buffer_load_dwordx4 v36, s[40:43], s58 offen nt lds
    s_waitcnt vmcnt(7)
    s_add_u32 m0, s7, 3072
    s_mov_b32 s58, 196608
    buffer_load_dwordx4 v36, s[40:43], s58 offen nt lds
    s_waitcnt vmcnt(7)
    s_add_u32 m0, s7, 4096
    s_mov_b32 s58, 262144
    buffer_load_dwordx4 v36, s[40:43], s58 offen nt lds
    s_bitcmp1_b32 s50, 0
    s_cbranch_scc0 L_xs4
    s_mov_b32 m0, s51
    s_addk_i32 s51, 1088
    buffer_load_dwordx4 v3, s[44:47], s64 offen nt lds
    s_add_u32 s64, s64, s62
    s_xor_b32 s62, s62, s63
    s_xor_b64 s[44:45], s[44:45], s[48:49]
L_xs4:
    s_bitcmp1_b32 s50, 1
    s_cbranch_scc0 L_xs5
    s_mov_b32 m0, s51
    s_addk_i32 s51, 1088
    buffer_load_dwordx4 v3, s[44:47], s64 offen nt lds
    s_add_u32 s64, s64, s62
    s_xor_b32 s62, s62, s63
    s_xor_b64 s[44:45], s[44:45], s[48:49]
L_xs5:
    s_bitcmp1_b32 s50, 2
    s_cbranch_scc0 L_xs6
    s_mov_b32 m0, s51
    s_addk_i32 s51, 1088
    buffer_load_dwordx4 v3, s[44:47], s64 offen nt lds
    s_add_u32 s64, s64, s62
    s_xor_b32 s62, s62, s63
    s_xor_b64 s[44:45], s[44:45], s[48:49]
L_xs6:
    s_bitcmp1_b32 s50, 3
    s_cbranch_scc0 L_xs7
    s_mov_b32 m0, s51
    s_addk_i32 s51, 1088
    buffer_load_dwordx4 v3, s[44:47], s64 offen nt lds
    s_add_u32 s64, s64, s62
    s_xor_b32 s62, s62, s63
    s_xor_b64 s[44:45], s[44:45], s[48:49]
L_xs7:
    s_bitcmp1_b32 s50, 4
    s_cbranch_scc0 L_xs8
    s_mov_b32 m0, s51
    s_addk_i32 s51, 1088
    buffer_load_dwordx4 v3, s[44:47], s64 offen nt lds
    s_add_u32 s64, s64, s62
    s_xor_b32 s62, s62, s63
    s_xor_b64 s[44:45], s[44:45], s[48:49]
L_xs8:
    s_getpc_b64 s[58:59]
L_pc9:
    s_lshr_b32 s57, s2, 3
    s_and_b32 s57, s57, 7
    s_lshl_b32 s57, s57, 2
    s_add_u32 s57, s57, s3
    s_mul_i32 s57, s57, 896
    v_lshl_add_u32 v84, v1, 7, s57
    s_mov_b64 exec, 0x7f
    global_load_dword v92, v84, s[58:59]
    s_mov_b64 exec, -1
    s_waitcnt vmcnt(8)
    s_xor_b32 s6, s97, 20480
    buffer_load_dwordx4 v[116:119], v2, s[32:35], s6 offen nt
    s_getreg_b32 s98, hwreg(HW_REG_XCC_ID, 0, 4)
    s_add_u32 s98, s98, 1
    s_lshr_b32 s59, s2, 3
    s_or_b32 s59, s59, s3
    s_cbranch_scc1 L_lf10
    s_lshl_b32 s58, s99, 5
    v_mov_b32 v86, s58
    v_mov_b32 v87, s98
    s_mov_b64 exec, 1
    global_store_dword v86, v87, s[28:29] sc1
    s_mov_b64 exec, -1
L_lf10:
    s_waitcnt vmcnt(8)
    s_xor_b32 s6, s97, 24576
    buffer_load_dwordx4 v[120:123], v2, s[32:35], s6 offen nt
    v_and_b32 v86, 1, v1
    v_mov_b32 v87, 0xffff
    v_lshlrev_b32 v86, 4, v86
    v_lshlrev_b32 v86, v86, v87
    v_bfe_u32 v87, v1, 1, 2
    v_cmp_eq_u32 s[58:59], 0, v87
    s_nop 1
    v_cndmask_b32 v4, 0, v86, s[58:59]
    v_cmp_eq_u32 s[58:59], 1, v87
    s_nop 1
    v_cndmask_b32 v5, 0, v86, s[58:59]
    v_cmp_eq_u32 s[58:59], 2, v87
    s_nop 1
    v_cndmask_b32 v6, 0, v86, s[58:59]
    v_cmp_eq_u32 s[58:59], 3, v87
    s_nop 1
    v_cndmask_b32 v7, 0, v86, s[58:59]
    s_waitcnt vmcnt(8)
    s_xor_b32 s6, s97, 28672
    buffer_load_dwordx4 v[124:127], v2, s[32:35], s6 offen nt
    s_waitcnt vmcnt(8)
    s_xor_b32 s6, s97, 32768
    buffer_load_dwordx4 v[128:131], v2, s[32:35], s6 offen nt
    s_waitcnt vmcnt(8)
    s_xor_b32 s6, s97, 36864
    buffer_load_dwordx4 v[132:135], v2, s[32:35], s6 offen nt
    s_waitcnt vmcnt(8)
    s_xor_b32 s6, s97, 40960
    buffer_load_dwordx4 v[136:139], v2, s[32:35], s6 offen nt
    global_load_dwordx2 v[52:53], v37, s[8:9] offset:0
    global_load_dwordx2 v[54:55], v37, s[8:9] offset:256
    global_load_dwordx2 v[56:57], v37, s[8:9] offset:512
    global_load_dwordx2 v[58:59], v37, s[8:9] offset:768
    global_load_dwordx2 v[60:61], v37, s[8:9] offset:1024
    s_waitcnt vmcnt(13)
    s_xor_b32 s6, s97, 45056
    buffer_load_dwordx4 v[140:143], v2, s[32:35], s6 offen nt
    s_waitcnt vmcnt(11)
    s_bitcmp1_b32 s54, 3
    s_cbranch_scc1 L_w11
    s_waitcnt vmcnt(10)
    s_bitcmp1_b32 s53, 3
    s_cbranch_scc1 L_w11
    s_waitcnt vmcnt(9)
    s_bitcmp1_b32 s52, 3
    s_cbranch_scc1 L_w11
    s_waitcnt vmcnt(8)
L_w11:
    s_xor_b32 s6, s97, 49152
    buffer_load_dwordx4 v[144:147], v2, s[32:35], s6 offen nt
    s_waitcnt vmcnt(11)
    s_bitcmp1_b32 s54, 3
    s_cbranch_scc1 L_w12
    s_waitcnt vmcnt(10)
    s_bitcmp1_b32 s53, 3
    s_cbranch_scc1 L_w12
    s_waitcnt vmcnt(9)
    s_bitcmp1_b32 s52, 3
    s_cbranch_scc1 L_w12
    s_waitcnt vmcnt(8)
L_w12:
    s_xor_b32 s6, s97, 53248
    buffer_load_dwordx4 v[148:151], v2, s[32:35], s6 offen nt
    s_waitcnt vmcnt(11)
    s_bitcmp1_b32 s54, 3
    s_cbranch_scc1 L_w13
    s_waitcnt vmcnt(10)
    s_bitcmp1_b32 s53, 3
    s_cbranch_scc1 L_w13
    s_waitcnt vmcnt(9)
    s_bitcmp1_b32 s52, 3
    s_cbranch_scc1 L_w13
    s_waitcnt vmcnt(8)
L_w13:
    s_xor_b32 s6, s97, 57344
    buffer_load_dwordx4 v[152:155], v2, s[32:35], s6 offen nt
    s_waitcnt vmcnt(11)
    s_bitcmp1_b32 s54, 3
    s_cbranch_scc1 L_w14
    s_waitcnt vmcnt(10)
    s_bitcmp1_b32 s53, 3
    s_cbranch_scc1 L_w14
    s_waitcnt vmcnt(9)
    s_bitcmp1_b32 s52, 3
    s_cbranch_scc1 L_w14
    s_waitcnt vmcnt(3)
L_w14:
    s_xor_b32 s6, s97, 61440
    buffer_load_dwordx4 v[156:159], v2, s[32:35], s6 offen nt
    s_waitcnt vmcnt(11)
    s_bitcmp1_b32 s54, 4
    s_cbranch_scc1 L_w15
    s_waitcnt vmcnt(10)
    s_bitcmp1_b32 s53, 4
    s_cbranch_scc1 L_w15
    s_waitcnt vmcnt(4)
    s_bitcmp1_b32 s52, 4
    s_cbranch_scc1 L_w15
    s_waitcnt vmcnt(3)
L_w15:
    s_xor_b32 s6, s97, 65536
    buffer_load_dwordx4 v[160:163], v2, s[32:35], s6 offen nt
    s_waitcnt vmcnt(11)
    s_bitcmp1_b32 s54, 4
    s_cbranch_scc1 L_w16
    s_waitcnt vmcnt(5)
    s_bitcmp1_b32 s53, 4
    s_cbranch_scc1 L_w16
    s_waitcnt vmcnt(4)
    s_bitcmp1_b32 s52, 4
    s_cbranch_scc1 L_w16
    s_waitcnt vmcnt(3)
L_w16:
    s_xor_b32 s6, s97, 69632
    buffer_load_dwordx4 v[164:167], v2, s[32:35], s6 offen nt
    s_waitcnt vmcnt(6)
    s_bitcmp1_b32 s54, 4
    s_cbranch_scc1 L_w17
    s_waitcnt vmcnt(5)
    s_bitcmp1_b32 s53, 4
    s_cbranch_scc1 L_w17
    s_waitcnt vmcnt(4)
    s_bitcmp1_b32 s52, 4
    s_cbranch_scc1 L_w17
    s_waitcnt vmcnt(3)
L_w17:
    s_xor_b32 s6, s97, 73728
    buffer_load_dwordx4 v[168:171], v2, s[32:35], s6 offen nt
    v_add_u32 v86, 123904, v91
    ds_write_b64 v86, v[52:53] offset:0
    ds_write_b64 v86, v[54:55] offset:256
    ds_write_b64 v86, v[56:57] offset:512
    ds_write_b64 v86, v[58:59] offset:768
    ds_write_b64 v86, v[60:61] offset:1024
    v_lshlrev_b32 v62, 16, v52
    v_and_b32 v63, 0xffff0000, v52
    v_lshlrev_b32 v64, 16, v53
    v_and_b32 v65, 0xffff0000, v53
    v_lshlrev_b32 v66, 16, v54
    v_and_b32 v67, 0xffff0000, v54
    v_lshlrev_b32 v68, 16, v55
    v_and_b32 v69, 0xffff0000, v55
    v_lshlrev_b32 v70, 16, v56
    v_and_b32 v71, 0xffff0000, v56
    v_lshlrev_b32 v72, 16, v57
    v_and_b32 v73, 0xffff0000, v57
    v_lshlrev_b32 v74, 16, v58
    v_and_b32 v75, 0xffff0000, v58
    v_lshlrev_b32 v76, 16, v59
    v_and_b32 v77, 0xffff0000, v59
    v_lshlrev_b32 v78, 16, v60
    v_and_b32 v79, 0xffff0000, v60
    v_lshlrev_b32 v80, 16, v61
    v_and_b32 v81, 0xffff0000, v61
    s_waitcnt vmcnt(6)
    s_bitcmp1_b32 s54, 4
    s_cbranch_scc1 L_w18
    s_waitcnt vmcnt(5)
    s_bitcmp1_b32 s53, 4
    s_cbranch_scc1 L_w18
    s_waitcnt vmcnt(4)
    s_bitcmp1_b32 s52, 4
    s_cbranch_scc1 L_w18
    s_waitcnt vmcnt(3)
L_w18:
    s_xor_b32 s6, s97, 77824
    buffer_load_dwordx4 v[172:175], v2, s[32:35], s6 offen nt
    v_pk_add_f32 v[82:83], v[62:63], v[64:65]
    v_pk_add_f32 v[82:83], v[82:83], v[66:67]
    v_pk_add_f32 v[82:83], v[82:83], v[68:69]
    v_pk_add_f32 v[82:83], v[82:83], v[70:71]
    v_pk_add_f32 v[82:83], v[82:83], v[72:73]
    v_pk_add_f32 v[82:83], v[82:83], v[74:75]
    v_pk_add_f32 v[82:83], v[82:83], v[76:77]
    v_pk_add_f32 v[82:83], v[82:83], v[78:79]
    v_pk_add_f32 v[82:83], v[82:83], v[80:81]
    v_add_f32 v82, v82, v83
    s_nop 1
    v_add_f32_dpp v82, v82, v82 row_ror:8 row_mask:0xf bank_mask:0xf
    s_nop 1
    v_add_f32_dpp v82, v82, v82 row_ror:4 row_mask:0xf bank_mask:0xf
    s_nop 1
    v_add_f32_dpp v82, v82, v82 row_ror:2 row_mask:0xf bank_mask:0xf
    s_nop 1
    v_add_f32_dpp v82, v82, v82 row_ror:1 row_mask:0xf bank_mask:0xf
    v_mov_b32 v83, v82
    s_nop 1
    v_permlane16_swap_b32 v82, v83
    v_add_f32 v82, v82, v83
    v_mul_f32 v82, 0x3acccccd, v82
    s_waitcnt vmcnt(6)
    s_bitcmp1_b32 s54, 5
    s_cbranch_scc1 L_w19
    s_waitcnt vmcnt(5)
    s_bitcmp1_b32 s53, 5
    s_cbranch_scc1 L_w19
    s_waitcnt vmcnt(4)
    s_bitcmp1_b32 s52, 5
    s_cbranch_scc1 L_w19
    s_waitcnt vmcnt(3)
L_w19:
    s_xor_b32 s6, s97, 81920
    buffer_load_dwordx4 v[176:179], v2, s[32:35], s6 offen nt
    v_mov_b32 v84, 0
    v_mov_b32 v85, 0
    v_mov_b32 v83, v82
    v_pk_add_f32 v[86:87], v[62:63], v[82:83] neg_lo:[0,1] neg_hi:[0,1]
    v_pk_fma_f32 v[84:85], v[86:87], v[86:87], v[84:85]
    v_pk_add_f32 v[86:87], v[64:65], v[82:83] neg_lo:[0,1] neg_hi:[0,1]
    v_pk_fma_f32 v[84:85], v[86:87], v[86:87], v[84:85]
    v_pk_add_f32 v[86:87], v[66:67], v[82:83] neg_lo:[0,1] neg_hi:[0,1]
    v_pk_fma_f32 v[84:85], v[86:87], v[86:87], v[84:85]
    v_pk_add_f32 v[86:87], v[68:69], v[82:83] neg_lo:[0,1] neg_hi:[0,1]
    v_pk_fma_f32 v[84:85], v[86:87], v[86:87], v[84:85]
    v_pk_add_f32 v[86:87], v[70:71], v[82:83] neg_lo:[0,1] neg_hi:[0,1]
    v_pk_fma_f32 v[84:85], v[86:87], v[86:87], v[84:85]
    v_pk_add_f32 v[86:87], v[72:73], v[82:83] neg_lo:[0,1] neg_hi:[0,1]
    v_pk_fma_f32 v[84:85], v[86:87], v[86:87], v[84:85]
    v_pk_add_f32 v[86:87], v[74:75], v[82:83] neg_lo:[0,1] neg_hi:[0,1]
    v_pk_fma_f32 v[84:85], v[86:87], v[86:87], v[84:85]
    v_pk_add_f32 v[86:87], v[76:77], v[82:83] neg_lo:[0,1] neg_hi:[0,1]
    v_pk_fma_f32 v[84:85], v[86:87], v[86:87], v[84:85]
    v_pk_add_f32 v[86:87], v[78:79], v[82:83] neg_lo:[0,1] neg_hi:[0,1]
    v_pk_fma_f32 v[84:85], v[86:87], v[86:87], v[84:85]
    v_pk_add_f32 v[86:87], v[80:81], v[82:83] neg_lo:[0,1] neg_hi:[0,1]
    v_pk_fma_f32 v[84:85], v[86:87], v[86:87], v[84:85]
    s_waitcnt vmcnt(6)
    s_bitcmp1_b32 s54, 5
    s_cbranch_scc1 L_w20
    s_waitcnt vmcnt(5)
    s_bitcmp1_b32 s53, 5
    s_cbranch_scc1 L_w20
    s_waitcnt vmcnt(4)
    s_bitcmp1_b32 s52, 5
    s_cbranch_scc1 L_w20
    s_waitcnt vmcnt(3)
L_w20:
    s_xor_b32 s6, s97, 86016
    buffer_load_dwordx4 v[180:183], v2, s[32:35], s6 offen nt
    v_add_f32 v84, v84, v85
    s_nop 1
    v_add_f32_dpp v84, v84, v84 row_ror:8 row_mask:0xf bank_mask:0xf
    s_nop 1
    v_add_f32_dpp v84, v84, v84 row_ror:4 row_mask:0xf bank_mask:0xf
    s_nop 1
    v_add_f32_dpp v84, v84, v84 row_ror:2 row_mask:0xf bank_mask:0xf
    s_nop 1
    v_add_f32_dpp v84, v84, v84 row_ror:1 row_mask:0xf bank_mask:0xf
    v_mov_b32 v85, v84
    s_nop 1
    v_permlane16_swap_b32 v84, v85
    v_add_f32 v84, v84, v85
    v_mul_f32 v84, 0x3acccccd, v84
    v_cvt_pk_bf16_f32 v84, v84, v84
    v_lshlrev_b32 v84, 16, v84
    v_add_f32 v84, 0x3727c5ac, v84
    v_cvt_pk_bf16_f32 v84, v84, v84
    v_lshlrev_b32 v84, 16, v84
    v_sqrt_f32 v84, v84
    s_nop 0
    v_cvt_pk_bf16_f32 v84, v84, v84
    v_lshlrev_b32 v84, 16, v84
    v_rcp_f32 v84, v84
    v_cvt_pk_bf16_f32 v82, v82, v82
    v_lshlrev_b32 v82, 16, v82
    v_mov_b32 v83, v82
    v_mov_b32 v85, v84
    s_waitcnt vmcnt(6)
    s_bitcmp1_b32 s54, 5
    s_cbranch_scc1 L_w21
    s_waitcnt vmcnt(5)
    s_bitcmp1_b32 s53, 5
    s_cbranch_scc1 L_w21
    s_waitcnt vmcnt(4)
    s_bitcmp1_b32 s52, 5
    s_cbranch_scc1 L_w21
    s_waitcnt vmcnt(3)
L_w21:
    s_xor_b32 s6, s97, 90112
    buffer_load_dwordx4 v[184:187], v2, s[32:35], s6 offen nt
    v_pk_add_f32 v[62:63], v[62:63], v[82:83] neg_lo:[0,1] neg_hi:[0,1]
    v_cvt_pk_bf16_f32 v86, v62, v63
    v_lshlrev_b32 v62, 16, v86
    v_and_b32 v63, 0xffff0000, v86
    v_pk_mul_f32 v[62:63], v[62:63], v[84:85]
    v_cvt_pk_bf16_f32 v52, v62, v63
    v_pk_add_f32 v[64:65], v[64:65], v[82:83] neg_lo:[0,1] neg_hi:[0,1]
    v_cvt_pk_bf16_f32 v86, v64, v65
    v_lshlrev_b32 v64, 16, v86
    v_and_b32 v65, 0xffff0000, v86
    v_pk_mul_f32 v[64:65], v[64:65], v[84:85]
    v_cvt_pk_bf16_f32 v53, v64, v65
    ds_write_b64 v91, v[52:53] offset:0
    s_waitcnt vmcnt(6)
    s_bitcmp1_b32 s54, 5
    s_cbranch_scc1 L_w22
    s_waitcnt vmcnt(5)
    s_bitcmp1_b32 s53, 5
    s_cbranch_scc1 L_w22
    s_waitcnt vmcnt(4)
    s_bitcmp1_b32 s52, 5
    s_cbranch_scc1 L_w22
    s_waitcnt vmcnt(3)
L_w22:
    s_xor_b32 s6, s97, 94208
    buffer_load_dwordx4 v[188:191], v2, s[32:35], s6 offen nt
    v_pk_add_f32 v[66:67], v[66:67], v[82:83] neg_lo:[0,1] neg_hi:[0,1]
    v_cvt_pk_bf16_f32 v86, v66, v67
    v_lshlrev_b32 v66, 16, v86
    v_and_b32 v67, 0xffff0000, v86
    v_pk_mul_f32 v[66:67], v[66:67], v[84:85]
    v_cvt_pk_bf16_f32 v54, v66, v67
    v_pk_add_f32 v[68:69], v[68:69], v[82:83] neg_lo:[0,1] neg_hi:[0,1]
    v_cvt_pk_bf16_f32 v86, v68, v69
    v_lshlrev_b32 v68, 16, v86
    v_and_b32 v69, 0xffff0000, v86
    v_pk_mul_f32 v[68:69], v[68:69], v[84:85]
    v_cvt_pk_bf16_f32 v55, v68, v69
    ds_write_b64 v91, v[54:55] offset:256
    v_pk_add_f32 v[70:71], v[70:71], v[82:83] neg_lo:[0,1] neg_hi:[0,1]
    v_cvt_pk_bf16_f32 v86, v70, v71
    v_lshlrev_b32 v70, 16, v86
    v_and_b32 v71, 0xffff0000, v86
    v_pk_mul_f32 v[70:71], v[70:71], v[84:85]
    v_cvt_pk_bf16_f32 v56, v70, v71
    v_pk_add_f32 v[72:73], v[72:73], v[82:83] neg_lo:[0,1] neg_hi:[0,1]
    v_cvt_pk_bf16_f32 v86, v72, v73
    v_lshlrev_b32 v72, 16, v86
    v_and_b32 v73, 0xffff0000, v86
    v_pk_mul_f32 v[72:73], v[72:73], v[84:85]
    v_cvt_pk_bf16_f32 v57, v72, v73
    ds_write_b64 v91, v[56:57] offset:512
    s_waitcnt vmcnt(6)
    s_bitcmp1_b32 s54, 6
    s_cbranch_scc1 L_w23
    s_waitcnt vmcnt(5)
    s_bitcmp1_b32 s53, 6
    s_cbranch_scc1 L_w23
    s_waitcnt vmcnt(4)
    s_bitcmp1_b32 s52, 6
    s_cbranch_scc1 L_w23
    s_waitcnt vmcnt(3)
L_w23:
    s_xor_b32 s6, s97, 98304
    buffer_load_dwordx4 v[192:195], v2, s[32:35], s6 offen nt
    v_pk_add_f32 v[74:75], v[74:75], v[82:83] neg_lo:[0,1] neg_hi:[0,1]
    v_cvt_pk_bf16_f32 v86, v74, v75
    v_lshlrev_b32 v74, 16, v86
    v_and_b32 v75, 0xffff0000, v86
    v_pk_mul_f32 v[74:75], v[74:75], v[84:85]
    v_cvt_pk_bf16_f32 v58, v74, v75
    v_pk_add_f32 v[76:77], v[76:77], v[82:83] neg_lo:[0,1] neg_hi:[0,1]
    v_cvt_pk_bf16_f32 v86, v76, v77
    v_lshlrev_b32 v76, 16, v86
    v_and_b32 v77, 0xffff0000, v86
    v_pk_mul_f32 v[76:77], v[76:77], v[84:85]
    v_cvt_pk_bf16_f32 v59, v76, v77
    ds_write_b64 v91, v[58:59] offset:768
    v_pk_add_f32 v[78:79], v[78:79], v[82:83] neg_lo:[0,1] neg_hi:[0,1]
    v_cvt_pk_bf16_f32 v86, v78, v79
    v_lshlrev_b32 v78, 16, v86
    v_and_b32 v79, 0xffff0000, v86
    v_pk_mul_f32 v[78:79], v[78:79], v[84:85]
    v_cvt_pk_bf16_f32 v60, v78, v79
    v_pk_add_f32 v[80:81], v[80:81], v[82:83] neg_lo:[0,1] neg_hi:[0,1]
    v_cvt_pk_bf16_f32 v86, v80, v81
    v_lshlrev_b32 v80, 16, v86
    v_and_b32 v81, 0xffff0000, v86
    v_pk_mul_f32 v[80:81], v[80:81], v[84:85]
    v_cvt_pk_bf16_f32 v61, v80, v81
    ds_write_b64 v91, v[60:61] offset:1024
    s_waitcnt vmcnt(6)
    s_bitcmp1_b32 s54, 6
    s_cbranch_scc1 L_w24
    s_waitcnt vmcnt(5)
    s_bitcmp1_b32 s53, 6
    s_cbranch_scc1 L_w24
    s_waitcnt vmcnt(4)
    s_bitcmp1_b32 s52, 6
    s_cbranch_scc1 L_w24
    s_waitcnt vmcnt(3)
L_w24:
    s_xor_b32 s6, s97, 102400
    buffer_load_dwordx4 v[196:199], v2, s[32:35], s6 offen nt
    v_lshrrev_b32 v54, 4, v1
    v_bfe_u32 v55, v1, 2, 2
    v_lshl_add_u32 v55, v54, 3, v55
    v_lshlrev_b32 v52, 7, v55
    v_and_b32 v55, 3, v1
    v_lshl_add_u32 v52, v55, 4, v52
    s_and_b32 s59, s3, 1
    s_mul_i32 s59, s59, 24
    s_lshl_b32 s58, s3, 5
    s_sub_u32 s58, s58, s59
    s_add_u32 s58, s58, 16384
    v_add_u32 v52, s58, v52
    v_and_b32 v55, 7, v1
    v_mul_u32_u24 v53, 1312, v55
    v_lshl_add_u32 v53, v54, 4, v53
    s_mul_i32 s58, s56, 320
    v_add_u32 v53, s58, v53
    v_lshlrev_b32 v55, 11, v55
    v_and_b32 v86, 1, v54
    v_lshl_add_u32 v55, v86, 10, v55
    v_lshrrev_b32 v54, 1, v54
    v_lshl_add_u32 v54, v54, 4, v55
    s_and_b32 s58, s5, 31
    s_lshl_b32 s58, s58, 14
    s_lshl_b32 s59, s4, 7
    s_add_u32 s58, s58, s59
    s_lshl_b32 s59, s3, 5
    s_add_u32 s58, s58, s59
    s_add_u32 s58, s58, 0
    v_add_u32 v54, s58, v54
    s_and_b32 s59, s3, 1
    s_mul_i32 s59, s59, 992
    s_add_u32 s58, s58, s59
    v_and_b32 v54, 15, v1
    v_lshl_add_u32 v54, v54, 2, s58
    v_lshl_add_u32 v54, v86, 13, v54
    v_lshrrev_b32 v86, 5, v1
    v_lshl_add_u32 v54, v86, 12, v54
    s_waitcnt vmcnt(6)
    s_bitcmp1_b32 s54, 6
    s_cbranch_scc1 L_w25
    s_waitcnt vmcnt(5)
    s_bitcmp1_b32 s53, 6
    s_cbranch_scc1 L_w25
    s_waitcnt vmcnt(4)
    s_bitcmp1_b32 s52, 6
    s_cbranch_scc1 L_w25
    s_waitcnt vmcnt(3)
L_w25:
    s_xor_b32 s6, s97, 106496
    buffer_load_dwordx4 v[200:203], v2, s[32:35], s6 offen nt
    s_waitcnt lgkmcnt(0)
    s_barrier
    ds_read_b64_tr_b16 v[12:13], v52 offset:0
    ds_read_b64_tr_b16 v[14:15], v52 offset:512
    ds_read_b128 v[32:35], v53 offset:0
    ds_read_b64_tr_b16 v[16:17], v52 offset:4096
    ds_read_b64_tr_b16 v[18:19], v52 offset:4608
    ds_read_b128 v[36:39], v53 offset:64
    ds_read_b64_tr_b16 v[20:21], v52 offset:8192
    ds_read_b64_tr_b16 v[22:23], v52 offset:8704
    ds_read_b128 v[40:43], v53 offset:128
    ds_read_b64_tr_b16 v[24:25], v52 offset:12288
    ds_read_b64_tr_b16 v[26:27], v52 offset:12800
    ds_read_b128 v[44:47], v53 offset:192
    ds_read_b64_tr_b16 v[28:29], v52 offset:16384
    ds_read_b64_tr_b16 v[30:31], v52 offset:16896
    ds_read_b128 v[48:51], v53 offset:256
    s_waitcnt vmcnt(6)
    s_bitcmp1_b32 s54, 6
    s_cbranch_scc1 L_w26
    s_waitcnt vmcnt(5)
    s_bitcmp1_b32 s53, 6
    s_cbranch_scc1 L_w26
    s_waitcnt vmcnt(4)
    s_bitcmp1_b32 s52, 6
    s_cbranch_scc1 L_w26
    s_waitcnt vmcnt(3)
L_w26:
    s_xor_b32 s6, s97, 110592
    buffer_load_dwordx4 v[204:207], v2, s[32:35], s6 offen nt
    s_waitcnt lgkmcnt(0)
    v_mfma_f32_16x16x32_bf16 v[56:59], v[32:35], v[12:15], 0
    v_mfma_f32_16x16x32_bf16 v[56:59], v[36:39], v[16:19], v[56:59]
    v_mfma_f32_16x16x32_bf16 v[56:59], v[40:43], v[20:23], v[56:59]
    v_mfma_f32_16x16x32_bf16 v[56:59], v[44:47], v[24:27], v[56:59]
    v_mfma_f32_16x16x32_bf16 v[56:59], v[48:51], v[28:31], v[56:59]
    s_mul_i32 s58, s99, 5632
    s_lshr_b32 s59, s2, 3
    s_lshl_b32 s59, s59, 2
    s_add_u32 s58, s58, s59
    s_add_u32 s58, s58, s3
    s_add_u32 s58, s58, 615424
    v_mov_b32 v55, s58
    s_cmp_eq_u32 s60, 0
    s_cselect_b32 s59, 0, 128
    s_add_u32 s58, s58, s59
    v_mov_b32 v72, s58
    v_mov_b32 v60, -1
    v_mov_b32 v61, 1
    s_mov_b32 s58, 0
    s_mov_b32 s59, -1
    v_cndmask_b32 v56, v56, v58, s[58:59]
    v_cndmask_b32 v57, v57, v59, s[58:59]
    s_waitcnt vmcnt(6)
    s_bitcmp1_b32 s54, 7
    s_cbranch_scc1 L_w27
    s_waitcnt vmcnt(5)
    s_bitcmp1_b32 s53, 7
    s_cbranch_scc1 L_w27
    s_waitcnt vmcnt(4)
    s_bitcmp1_b32 s52, 7
    s_cbranch_scc1 L_w27
    s_waitcnt vmcnt(3)
L_w27:
    s_xor_b32 s6, s97, 114688
    buffer_load_dwordx4 v[208:211], v2, s[32:35], s6 offen nt
    s_lshl_b32 s58, s3, 4
    s_lshl_b64 exec, 0xffff, s58
    global_store_dword v93, v60, s[30:31]
    s_mov_b64 exec, -1
    global_store_dword v54, v56, s[30:31]
    global_store_dword v54, v57, s[30:31] offset:2048
    v_and_b32 v88, 7, v1
    v_lshlrev_b32 v88, 5, v88
    global_load_dword v90, v88, s[28:29] sc1
    s_waitcnt vmcnt(10)
    s_bitcmp1_b32 s54, 7
    s_cbranch_scc1 L_w28
    s_waitcnt vmcnt(9)
    s_bitcmp1_b32 s53, 7
    s_cbranch_scc1 L_w28
    s_waitcnt vmcnt(8)
    s_bitcmp1_b32 s52, 7
    s_cbranch_scc1 L_w28
    s_waitcnt vmcnt(7)
L_w28:
    s_xor_b32 s6, s97, 118784
    buffer_load_dwordx4 v[212:215], v2, s[32:35], s6 offen nt
    s_waitcnt vmcnt(10)
    s_bitcmp1_b32 s54, 7
    s_cbranch_scc1 L_w29
    s_waitcnt vmcnt(9)
    s_bitcmp1_b32 s53, 7
    s_cbranch_scc1 L_w29
    s_waitcnt vmcnt(8)
    s_bitcmp1_b32 s52, 7
    s_cbranch_scc1 L_w29
    s_waitcnt vmcnt(7)
L_w29:
    s_xor_b32 s6, s97, 122880
    buffer_load_dwordx4 v[216:219], v2, s[32:35], s6 offen nt
    s_waitcnt vmcnt(10)
    s_bitcmp1_b32 s54, 7
    s_cbranch_scc1 L_w30
    s_waitcnt vmcnt(9)
    s_bitcmp1_b32 s53, 7
    s_cbranch_scc1 L_w30
    s_waitcnt vmcnt(8)
    s_bitcmp1_b32 s52, 7
    s_cbranch_scc1 L_w30
    s_waitcnt vmcnt(7)
L_w30:
    s_xor_b32 s6, s97, 126976
    buffer_load_dwordx4 v[220:223], v2, s[32:35], s6 offen nt
    s_waitcnt vmcnt(10)
    s_bitcmp1_b32 s54, 8
    s_cbranch_scc1 L_w31
    s_waitcnt vmcnt(9)
    s_bitcmp1_b32 s53, 8
    s_cbranch_scc1 L_w31
    s_waitcnt vmcnt(8)
    s_bitcmp1_b32 s52, 8
    s_cbranch_scc1 L_w31
    s_waitcnt vmcnt(7)
L_w31:
    s_xor_b32 s6, s97, 131072
    buffer_load_dwordx4 v[224:227], v2, s[32:35], s6 offen nt
    s_waitcnt vmcnt(10)
    s_bitcmp1_b32 s54, 8
    s_cbranch_scc1 L_w32
    s_waitcnt vmcnt(9)
    s_bitcmp1_b32 s53, 8
    s_cbranch_scc1 L_w32
    s_waitcnt vmcnt(8)
    s_bitcmp1_b32 s52, 8
    s_cbranch_scc1 L_w32
    s_waitcnt vmcnt(3)
L_w32:
    s_xor_b32 s6, s97, 135168
    buffer_load_dwordx4 v[228:231], v2, s[32:35], s6 offen nt
    s_waitcnt vmcnt(10)
    s_bitcmp1_b32 s54, 8
    s_cbranch_scc1 L_w33
    s_waitcnt vmcnt(9)
    s_bitcmp1_b32 s53, 8
    s_cbranch_scc1 L_w33
    s_waitcnt vmcnt(4)
    s_bitcmp1_b32 s52, 8
    s_cbranch_scc1 L_w33
    s_waitcnt vmcnt(3)
L_w33:
    s_xor_b32 s6, s97, 139264
    buffer_load_dwordx4 v[232:235], v2, s[32:35], s6 offen nt
    s_waitcnt vmcnt(10)
    s_bitcmp1_b32 s54, 8
    s_cbranch_scc1 L_w34
    s_waitcnt vmcnt(5)
    s_bitcmp1_b32 s53, 8
    s_cbranch_scc1 L_w34
    s_waitcnt vmcnt(4)
    s_bitcmp1_b32 s52, 8
    s_cbranch_scc1 L_w34
    s_waitcnt vmcnt(3)
L_w34:
    s_xor_b32 s6, s97, 143360
    buffer_load_dwordx4 v[236:239], v2, s[32:35], s6 offen nt
    s_waitcnt vmcnt(6)
    s_bitcmp1_b32 s54, 9
    s_cbranch_scc1 L_w35
    s_waitcnt vmcnt(5)
    s_bitcmp1_b32 s53, 9
    s_cbranch_scc1 L_w35
    s_waitcnt vmcnt(4)
    s_bitcmp1_b32 s52, 9
    s_cbranch_scc1 L_w35
    s_waitcnt vmcnt(3)
L_w35:
    s_xor_b32 s6, s97, 147456
    buffer_load_dwordx4 v[240:243], v2, s[32:35], s6 offen nt
    v_cmp_eq_u32 s[58:59], 0, v90
    s_cmp_lg_u32 s58, 0
    s_cbranch_scc1 L_dl36
L_dd37:
    v_readlane_b32 s58, v90, s99
    s_cmp_lg_u32 s58, s98
    s_cselect_b32 s98, 1, 0
    s_cmp_lg_u32 s98, 0
    s_cbranch_scc1 L_fs39
    s_mov_b64 exec, 1
    global_store_byte v55, v61, s[30:31]
    s_mov_b64 exec, -1
L_fj40:
    s_waitcnt vmcnt(7)
    s_bitcmp1_b32 s54, 9
    s_cbranch_scc1 L_w41
    s_waitcnt vmcnt(6)
    s_bitcmp1_b32 s53, 9
    s_cbranch_scc1 L_w41
    s_waitcnt vmcnt(5)
    s_bitcmp1_b32 s52, 9
    s_cbranch_scc1 L_w41
    s_waitcnt vmcnt(4)
L_w41:
    s_xor_b32 s6, s97, 151552
    buffer_load_dwordx4 v[244:247], v2, s[32:35], s6 offen nt
    s_waitcnt vmcnt(7)
    s_bitcmp1_b32 s54, 9
    s_cbranch_scc1 L_w42
    s_waitcnt vmcnt(6)
    s_bitcmp1_b32 s53, 9
    s_cbranch_scc1 L_w42
    s_waitcnt vmcnt(5)
    s_bitcmp1_b32 s52, 9
    s_cbranch_scc1 L_w42
    s_waitcnt vmcnt(4)
L_w42:
    s_xor_b32 s6, s97, 155648
    buffer_load_dwordx4 v[248:251], v2, s[32:35], s6 offen nt
    s_waitcnt vmcnt(7)
    s_bitcmp1_b32 s54, 9
    s_cbranch_scc1 L_w43
    s_waitcnt vmcnt(6)
    s_bitcmp1_b32 s53, 9
    s_cbranch_scc1 L_w43
    s_waitcnt vmcnt(5)
    s_bitcmp1_b32 s52, 9
    s_cbranch_scc1 L_w43
    s_waitcnt vmcnt(4)
L_w43:
    s_xor_b32 s6, s97, 159744
    buffer_load_dwordx4 v[252:255], v2, s[32:35], s6 offen nt
    s_waitcnt vmcnt(7)
    s_bitcmp1_b32 s54, 10
    s_cbranch_scc1 L_w44
    s_waitcnt vmcnt(6)
    s_bitcmp1_b32 s53, 10
    s_cbranch_scc1 L_w44
    s_waitcnt vmcnt(5)
    s_bitcmp1_b32 s52, 10
    s_cbranch_scc1 L_w44
    s_waitcnt vmcnt(4)
L_w44:
    s_xor_b32 s6, s97, 163840
    buffer_load_dwordx4 a[0:3], v2, s[32:35], s6 offen nt
    s_lshr_b32 s8, s13, 2
    s_sub_i32 s8, 24, s8
    v_mov_b32 v73, s8
    s_mov_b64 exec, 1
    global_store_byte v72, v73, s[30:31] offset:256
    s_mov_b64 exec, -1
    s_waitcnt vmcnt(8)
    s_bitcmp1_b32 s54, 10
    s_cbranch_scc1 L_w45
    s_waitcnt vmcnt(7)
    s_bitcmp1_b32 s53, 10
    s_cbranch_scc1 L_w45
    s_waitcnt vmcnt(6)
    s_bitcmp1_b32 s52, 10
    s_cbranch_scc1 L_w45
    s_waitcnt vmcnt(4)
L_w45:
    s_xor_b32 s6, s97, 167936
    buffer_load_dwordx4 a[4:7], v2, s[32:35], s6 offen nt
    s_waitcnt vmcnt(8)
    s_bitcmp1_b32 s54, 10
    s_cbranch_scc1 L_w46
    s_waitcnt vmcnt(7)
    s_bitcmp1_b32 s53, 10
    s_cbranch_scc1 L_w46
    s_waitcnt vmcnt(5)
    s_bitcmp1_b32 s52, 10
    s_cbranch_scc1 L_w46
    s_waitcnt vmcnt(4)
L_w46:
    s_xor_b32 s6, s97, 172032
    buffer_load_dwordx4 a[8:11], v2, s[32:35], s6 offen nt
    s_waitcnt vmcnt(8)
    s_bitcmp1_b32 s54, 10
    s_cbranch_scc1 L_w47
    s_waitcnt vmcnt(6)
    s_bitcmp1_b32 s53, 10
    s_cbranch_scc1 L_w47
    s_waitcnt vmcnt(5)
    s_bitcmp1_b32 s52, 10
    s_cbranch_scc1 L_w47
    s_waitcnt vmcnt(4)
L_w47:
    s_xor_b32 s6, s97, 176128
    buffer_load_dwordx4 a[12:15], v2, s[32:35], s6 offen nt
    s_waitcnt vmcnt(7)
    s_bitcmp1_b32 s54, 11
    s_cbranch_scc1 L_w48
    s_waitcnt vmcnt(6)
    s_bitcmp1_b32 s53, 11
    s_cbranch_scc1 L_w48
    s_waitcnt vmcnt(5)
    s_bitcmp1_b32 s52, 11
    s_cbranch_scc1 L_w48
    s_waitcnt vmcnt(4)
L_w48:
    s_xor_b32 s6, s97, 180224
    buffer_load_dwordx4 a[16:19], v2, s[32:35], s6 offen nt
    s_lshr_b32 s8, s13, 2
    s_sub_i32 s8, 32, s8
    v_mov_b32 v73, s8
    s_mov_b64 exec, 1
    global_store_byte v72, v73, s[30:31] offset:256
    s_mov_b64 exec, -1
    s_waitcnt vmcnt(8)
    s_bitcmp1_b32 s54, 11
    s_cbranch_scc1 L_w49
    s_waitcnt vmcnt(7)
    s_bitcmp1_b32 s53, 11
    s_cbranch_scc1 L_w49
    s_waitcnt vmcnt(6)
    s_bitcmp1_b32 s52, 11
    s_cbranch_scc1 L_w49
    s_waitcnt vmcnt(4)
L_w49:
    s_xor_b32 s6, s97, 184320
    buffer_load_dwordx4 a[20:23], v2, s[32:35], s6 offen nt
    s_waitcnt vmcnt(8)
    s_bitcmp1_b32 s54, 11
    s_cbranch_scc1 L_w50
    s_waitcnt vmcnt(7)
    s_bitcmp1_b32 s53, 11
    s_cbranch_scc1 L_w50
    s_waitcnt vmcnt(5)
    s_bitcmp1_b32 s52, 11
    s_cbranch_scc1 L_w50
    s_waitcnt vmcnt(4)
L_w50:
    s_xor_b32 s6, s97, 188416
    buffer_load_dwordx4 a[24:27], v2, s[32:35], s6 offen nt
    s_waitcnt vmcnt(8)
    s_bitcmp1_b32 s54, 11
    s_cbranch_scc1 L_w51
    s_waitcnt vmcnt(6)
    s_bitcmp1_b32 s53, 11
    s_cbranch_scc1 L_w51
    s_waitcnt vmcnt(5)
    s_bitcmp1_b32 s52, 11
    s_cbranch_scc1 L_w51
    s_waitcnt vmcnt(4)
L_w51:
    s_xor_b32 s6, s97, 192512
    buffer_load_dwordx4 a[28:31], v2, s[32:35], s6 offen nt
    s_waitcnt vmcnt(7)
    s_bitcmp1_b32 s54, 12
    s_cbranch_scc1 L_w52
    s_waitcnt vmcnt(6)
    s_bitcmp1_b32 s53, 12
    s_cbranch_scc1 L_w52
    s_waitcnt vmcnt(5)
    s_bitcmp1_b32 s52, 12
    s_cbranch_scc1 L_w52
    s_waitcnt vmcnt(4)
L_w52:
    s_xor_b32 s6, s97, 196608
    buffer_load_dwordx4 a[32:35], v2, s[32:35], s6 offen nt
    s_lshr_b32 s8, s13, 2
    s_sub_i32 s8, 40, s8
    v_mov_b32 v73, s8
    s_mov_b64 exec, 1
    global_store_byte v72, v73, s[30:31] offset:256
    s_mov_b64 exec, -1
    s_waitcnt vmcnt(8)
    s_bitcmp1_b32 s54, 12
    s_cbranch_scc1 L_w53
    s_waitcnt vmcnt(7)
    s_bitcmp1_b32 s53, 12
    s_cbranch_scc1 L_w53
    s_waitcnt vmcnt(6)
    s_bitcmp1_b32 s52, 12
    s_cbranch_scc1 L_w53
    s_waitcnt vmcnt(4)
L_w53:
    s_xor_b32 s6, s97, 200704
    buffer_load_dwordx4 a[36:39], v2, s[32:35], s6 offen nt
    s_waitcnt vmcnt(8)
    s_bitcmp1_b32 s54, 12
    s_cbranch_scc1 L_w54
    s_waitcnt vmcnt(7)
    s_bitcmp1_b32 s53, 12
    s_cbranch_scc1 L_w54
    s_waitcnt vmcnt(5)
    s_bitcmp1_b32 s52, 12
    s_cbranch_scc1 L_w54
    s_waitcnt vmcnt(4)
L_w54:
    s_xor_b32 s6, s97, 204800
    buffer_load_dwordx4 a[40:43], v2, s[32:35], s6 offen nt
    global_load_dword v74, v89, s[30:31] offset:256 nt
    s_lshr_b32 s8, s13, 2
    s_mul_i32 s8, s8, 80
    s_mul_i32 s9, s12, 50
    s_lshr_b32 s9, s9, 4
    s_add_u32 s8, s8, s9
    s_sub_i32 s10, 3240, s8
    s_waitcnt vmcnt(9)
    s_bitcmp1_b32 s54, 12
    s_cbranch_scc1 L_w55
    s_waitcnt vmcnt(7)
    s_bitcmp1_b32 s53, 12
    s_cbranch_scc1 L_w55
    s_waitcnt vmcnt(6)
    s_bitcmp1_b32 s52, 12
    s_cbranch_scc1 L_w55
    s_waitcnt vmcnt(5)
L_w55:
    s_xor_b32 s6, s97, 208896
    buffer_load_dwordx4 a[44:47], v2, s[32:35], s6 offen nt
    s_waitcnt vmcnt(8)
    s_bitcmp1_b32 s54, 13
    s_cbranch_scc1 L_w56
    s_waitcnt vmcnt(7)
    s_bitcmp1_b32 s53, 13
    s_cbranch_scc1 L_w56
    s_waitcnt vmcnt(6)
    s_bitcmp1_b32 s52, 13
    s_cbranch_scc1 L_w56
    s_waitcnt vmcnt(5)
L_w56:
    s_xor_b32 s6, s97, 212992
    buffer_load_dwordx4 a[48:51], v2, s[32:35], s6 offen nt
    s_lshr_b32 s8, s13, 2
    s_sub_i32 s8, 48, s8
    v_mov_b32 v73, s8
    s_mov_b64 exec, 1
    global_store_byte v72, v73, s[30:31] offset:256
    s_mov_b64 exec, -1
    s_waitcnt vmcnt(9)
    s_bitcmp1_b32 s54, 13
    s_cbranch_scc1 L_w57
    s_waitcnt vmcnt(8)
    s_bitcmp1_b32 s53, 13
    s_cbranch_scc1 L_w57
    s_waitcnt vmcnt(7)
    s_bitcmp1_b32 s52, 13
    s_cbranch_scc1 L_w57
    s_waitcnt vmcnt(5)
L_w57:
    s_xor_b32 s6, s97, 217088
    buffer_load_dwordx4 a[52:55], v2, s[32:35], s6 offen nt
    s_mov_b32 exec_hi, 0
    global_load_dword v53, v89, s[30:31] nt
    s_mov_b32 exec_hi, -1
    s_waitcnt vmcnt(10)
    s_bitcmp1_b32 s54, 13
    s_cbranch_scc1 L_w58
    s_waitcnt vmcnt(9)
    s_bitcmp1_b32 s53, 13
    s_cbranch_scc1 L_w58
    s_waitcnt vmcnt(7)
    s_bitcmp1_b32 s52, 13
    s_cbranch_scc1 L_w58
    s_waitcnt vmcnt(6)
L_w58:
    s_xor_b32 s6, s97, 221184
    buffer_load_dwordx4 a[56:59], v2, s[32:35], s6 offen nt
    s_waitcnt vmcnt(10)
    s_bitcmp1_b32 s54, 13
    s_cbranch_scc1 L_w59
    s_waitcnt vmcnt(8)
    s_bitcmp1_b32 s53, 13
    s_cbranch_scc1 L_w59
    s_waitcnt vmcnt(7)
    s_bitcmp1_b32 s52, 13
    s_cbranch_scc1 L_w59
    s_waitcnt vmcnt(5)
L_w59:
    s_xor_b32 s6, s97, 225280
    buffer_load_dwordx4 a[60:63], v2, s[32:35], s6 offen nt
    s_waitcnt vmcnt(9)
    s_bitcmp1_b32 s54, 14
    s_cbranch_scc1 L_w60
    s_waitcnt vmcnt(8)
    s_bitcmp1_b32 s53, 14
    s_cbranch_scc1 L_w60
    s_waitcnt vmcnt(6)
    s_bitcmp1_b32 s52, 14
    s_cbranch_scc1 L_w60
    s_waitcnt vmcnt(5)
L_w60:
    s_xor_b32 s6, s97, 229376
    buffer_load_dwordx4 a[64:67], v2, s[32:35], s6 offen nt
    s_lshr_b32 s8, s13, 2
    s_sub_i32 s8, 56, s8
    v_mov_b32 v73, s8
    s_mov_b64 exec, 1
    global_store_byte v72, v73, s[30:31] offset:256
    s_mov_b64 exec, -1
    s_waitcnt vmcnt(10)
    s_bitcmp1_b32 s54, 14
    s_cbranch_scc1 L_w61
    s_waitcnt vmcnt(8)
    s_bitcmp1_b32 s53, 14
    s_cbranch_scc1 L_w61
    s_waitcnt vmcnt(7)
    s_bitcmp1_b32 s52, 14
    s_cbranch_scc1 L_w61
    s_waitcnt vmcnt(5)
L_w61:
    s_xor_b32 s6, s97, 233472
    buffer_load_dwordx4 a[68:71], v2, s[32:35], s6 offen nt
    s_waitcnt vmcnt(9)
    s_bitcmp1_b32 s54, 14
    s_cbranch_scc1 L_w62
    s_waitcnt vmcnt(8)
    s_bitcmp1_b32 s53, 14
    s_cbranch_scc1 L_w62
    s_waitcnt vmcnt(6)
    s_bitcmp1_b32 s52, 14
    s_cbranch_scc1 L_w62
    s_waitcnt vmcnt(4)
L_w62:
    s_xor_b32 s6, s97, 237568
    buffer_load_dwordx4 a[72:75], v2, s[32:35], s6 offen nt
    v_readlane_b32 s57, v74, 32
    v_sad_u8 v74, v74, 0, 0
    s_nop 1
    v_add_u32_dpp v74, v74, v74 row_ror:8 row_mask:0xf bank_mask:0xf
    s_nop 1
    v_add_u32_dpp v74, v74, v74 row_ror:4 row_mask:0xf bank_mask:0xf
    s_nop 1
    v_add_u32_dpp v74, v74, v74 row_ror:2 row_mask:0xf bank_mask:0xf
    s_nop 1
    v_add_u32_dpp v74, v74, v74 row_ror:1 row_mask:0xf bank_mask:0xf
    s_nop 0
    v_readlane_b32 s8, v74, 0
    v_readlane_b32 s9, v74, 16
    s_add_u32 s8, s8, s9
    s_sub_i32 s8, s10, s8
    s_sub_i32 s8, s8, s57
    s_cmp_lg_u32 s98, 0
    s_cselect_b32 s8, 0, s8
    s_mul_i32 s8, s8, 19
    s_ashr_i32 s8, s8, 10
    s_sub_i32 s13, s1, s8
    s_max_i32 s13, s13, 5
    s_min_i32 s13, s13, 24
    s_and_b32 s58, s13, 7
    s_lshl_b32 s58, s58, 3
    s_lshr_b64 s[58:59], vcc, s58
    s_and_b32 s58, s58, 0xff
    s_mul_i32 s58, s58, 0x01010101
    s_mov_b32 s59, s58
    s_lshr_b64 s[58:59], s[58:59], s0
    s_cmp_ge_u32 s13, 8
    s_cselect_b32 s52, -1, s58
    s_cselect_b32 s53, s58, 0
    s_cmp_ge_u32 s13, 16
    s_cselect_b32 s53, -1, s53
    s_cselect_b32 s54, s58, 0
    s_cmp_ge_u32 s13, 24
    s_cselect_b32 s54, -1, s54
    global_load_dword v75, v89, s[30:31] offset:256 nt
    s_lshr_b32 s8, s13, 2
    s_mul_i32 s8, s8, 80
    s_mul_i32 s9, s12, 58
    s_lshr_b32 s9, s9, 4
    s_add_u32 s8, s8, s9
    s_sub_i32 s11, 4520, s8
    s_waitcnt vmcnt(10)
    s_bitcmp1_b32 s54, 14
    s_cbranch_scc1 L_w63
    s_waitcnt vmcnt(8)
    s_bitcmp1_b32 s53, 14
    s_cbranch_scc1 L_w63
    s_waitcnt vmcnt(6)
    s_bitcmp1_b32 s52, 14
    s_cbranch_scc1 L_w63
    s_waitcnt vmcnt(5)
L_w63:
    s_xor_b32 s6, s97, 241664
    buffer_load_dwordx4 a[76:79], v2, s[32:35], s6 offen nt
    s_waitcnt vmcnt(9)
    s_bitcmp1_b32 s54, 15
    s_cbranch_scc1 L_w64
    s_waitcnt vmcnt(7)
    s_bitcmp1_b32 s53, 15
    s_cbranch_scc1 L_w64
    s_waitcnt vmcnt(6)
    s_bitcmp1_b32 s52, 15
    s_cbranch_scc1 L_w64
    s_waitcnt vmcnt(5)
L_w64:
    s_xor_b32 s6, s97, 245760
    buffer_load_dwordx4 a[80:83], v2, s[32:35], s6 offen nt
    s_lshr_b32 s8, s13, 2
    s_sub_i32 s8, 64, s8
    v_mov_b32 v73, s8
    s_mov_b64 exec, 1
    global_store_byte v72, v73, s[30:31] offset:256
    s_mov_b64 exec, -1
    s_waitcnt vmcnt(9)
    s_bitcmp1_b32 s54, 15
    s_cbranch_scc1 L_w65
    s_waitcnt vmcnt(8)
    s_bitcmp1_b32 s53, 15
    s_cbranch_scc1 L_w65
    s_waitcnt vmcnt(7)
    s_bitcmp1_b32 s52, 15
    s_cbranch_scc1 L_w65
    s_waitcnt vmcnt(5)
L_w65:
    s_xor_b32 s6, s97, 249856
    buffer_load_dwordx4 a[84:87], v2, s[32:35], s6 offen nt
    s_mov_b32 s66, 0x01010101
    v_cmp_ne_u32 s[58:59], s66, v53
    s_or_b32 s58, s58, s98
    s_cbranch_scc1 L_pl66
L_pd67:
    v_lshlrev_b32 v52, 4, v1
    s_and_b32 s58, s5, 31
    s_lshl_b32 s58, s58, 14
    s_lshl_b32 s59, s4, 11
    s_add_u32 s58, s58, s59
    s_add_u32 s58, s58, s98
    s_add_u32 s58, s58, 0
    v_add_u32 v52, s58, v52
    s_cmp_lg_u32 s98, 0
    s_cbranch_scc1 L_qg71
    global_load_dwordx4 v[56:59], v52, s[30:31] nt
    global_load_dwordx4 v[60:63], v52, s[30:31] offset:1024 nt
L_qh72:
    s_waitcnt vmcnt(11)
    s_bitcmp1_b32 s54, 15
    s_cbranch_scc1 L_w73
    s_waitcnt vmcnt(10)
    s_bitcmp1_b32 s53, 15
    s_cbranch_scc1 L_w73
    s_waitcnt vmcnt(8)
    s_bitcmp1_b32 s52, 15
    s_cbranch_scc1 L_w73
    s_waitcnt vmcnt(7)
L_w73:
    s_xor_b32 s6, s97, 253952
    buffer_load_dwordx4 a[88:91], v2, s[32:35], s6 offen nt
    s_waitcnt vmcnt(11)
    s_bitcmp1_b32 s54, 15
    s_cbranch_scc1 L_w74
    s_waitcnt vmcnt(9)
    s_bitcmp1_b32 s53, 15
    s_cbranch_scc1 L_w74
    s_waitcnt vmcnt(8)
    s_bitcmp1_b32 s52, 15
    s_cbranch_scc1 L_w74
    s_waitcnt vmcnt(6)
L_w74:
    s_xor_b32 s6, s97, 258048
    buffer_load_dwordx4 a[92:95], v2, s[32:35], s6 offen nt
    s_waitcnt vmcnt(10)
    s_bitcmp1_b32 s54, 16
    s_cbranch_scc1 L_w75
    s_waitcnt vmcnt(9)
    s_bitcmp1_b32 s53, 16
    s_cbranch_scc1 L_w75
    s_waitcnt vmcnt(7)
    s_bitcmp1_b32 s52, 16
    s_cbranch_scc1 L_w75
    s_waitcnt vmcnt(6)
L_w75:
    s_xor_b32 s6, s97, 0
    buffer_load_dwordx4 a[96:99], v2, s[36:39], s6 offen nt
    s_lshr_b32 s8, s13, 2
    s_sub_i32 s8, 72, s8
    v_mov_b32 v73, s8
    s_mov_b64 exec, 1
    global_store_byte v72, v73, s[30:31] offset:256
    s_mov_b64 exec, -1
    s_waitcnt vmcnt(11)
    s_bitcmp1_b32 s54, 16
    s_cbranch_scc1 L_w76
    s_waitcnt vmcnt(9)
    s_bitcmp1_b32 s53, 16
    s_cbranch_scc1 L_w76
    s_waitcnt vmcnt(8)
    s_bitcmp1_b32 s52, 16
    s_cbranch_scc1 L_w76
    s_waitcnt vmcnt(6)
L_w76:
    s_xor_b32 s6, s97, 4096
    buffer_load_dwordx4 a[100:103], v2, s[36:39], s6 offen nt
    s_waitcnt vmcnt(10)
    s_bitcmp1_b32 s54, 16
    s_cbranch_scc1 L_w77
    s_waitcnt vmcnt(9)
    s_bitcmp1_b32 s53, 16
    s_cbranch_scc1 L_w77
    s_waitcnt vmcnt(7)
    s_bitcmp1_b32 s52, 16
    s_cbranch_scc1 L_w77
    s_waitcnt vmcnt(4)
L_w77:
    s_xor_b32 s6, s97, 8192
    buffer_load_dwordx4 a[104:107], v2, s[36:39], s6 offen nt
    v_readlane_b32 s57, v75, 32
    v_sad_u8 v75, v75, 0, 0
    s_nop 1
    v_add_u32_dpp v75, v75, v75 row_ror:8 row_mask:0xf bank_mask:0xf
    s_nop 1
    v_add_u32_dpp v75, v75, v75 row_ror:4 row_mask:0xf bank_mask:0xf
    s_nop 1
    v_add_u32_dpp v75, v75, v75 row_ror:2 row_mask:0xf bank_mask:0xf
    s_nop 1
    v_add_u32_dpp v75, v75, v75 row_ror:1 row_mask:0xf bank_mask:0xf
    s_nop 0
    v_readlane_b32 s8, v75, 0
    v_readlane_b32 s9, v75, 16
    s_add_u32 s8, s8, s9
    s_sub_i32 s8, s11, s8
    s_sub_i32 s8, s8, s57
    s_cmp_lg_u32 s98, 0
    s_cselect_b32 s8, 0, s8
    s_mul_i32 s8, s8, 19
    s_ashr_i32 s8, s8, 10
    s_sub_i32 s13, s1, s8
    s_max_i32 s13, s13, 5
    s_min_i32 s13, s13, 24
    s_and_b32 s58, s13, 7
    s_lshl_b32 s58, s58, 3
    s_lshr_b64 s[58:59], vcc, s58
    s_and_b32 s58, s58, 0xff
    s_mul_i32 s58, s58, 0x01010101
    s_mov_b32 s59, s58
    s_lshr_b64 s[58:59], s[58:59], s0
    s_cmp_ge_u32 s13, 8
    s_cselect_b32 s52, -1, s58
    s_cselect_b32 s53, s58, 0
    s_cmp_ge_u32 s13, 16
    s_cselect_b32 s53, -1, s53
    s_cselect_b32 s54, s58, 0
    s_cmp_ge_u32 s13, 24
    s_cselect_b32 s54, -1, s54
    global_load_dword v76, v89, s[30:31] offset:256 nt
    s_lshr_b32 s8, s13, 2
    s_mul_i32 s8, s8, 80
    s_mul_i32 s9, s12, 66
    s_lshr_b32 s9, s9, 4
    s_add_u32 s8, s8, s9
    s_sub_i32 s56, 5800, s8
    s_waitcnt vmcnt(11)
    s_bitcmp1_b32 s54, 16
    s_cbranch_scc1 L_w78
    s_waitcnt vmcnt(9)
    s_bitcmp1_b32 s53, 16
    s_cbranch_scc1 L_w78
    s_waitcnt vmcnt(6)
    s_bitcmp1_b32 s52, 16
    s_cbranch_scc1 L_w78
    s_waitcnt vmcnt(5)
L_w78:
    s_xor_b32 s6, s97, 12288
    buffer_load_dwordx4 a[108:111], v2, s[36:39], s6 offen nt
    s_waitcnt vmcnt(10)
    s_bitcmp1_b32 s54, 17
    s_cbranch_scc1 L_w79
    s_waitcnt vmcnt(7)
    s_bitcmp1_b32 s53, 17
    s_cbranch_scc1 L_w79
    s_waitcnt vmcnt(6)
    s_bitcmp1_b32 s52, 17
    s_cbranch_scc1 L_w79
    s_waitcnt vmcnt(5)
L_w79:
    s_xor_b32 s6, s97, 16384
    buffer_load_dwordx4 a[112:115], v2, s[36:39], s6 offen nt
    s_lshr_b32 s8, s13, 2
    s_sub_i32 s8, 80, s8
    v_mov_b32 v73, s8
    s_mov_b64 exec, 1
    global_store_byte v72, v73, s[30:31] offset:256
    s_mov_b64 exec, -1
    s_waitcnt vmcnt(9)
    s_bitcmp1_b32 s54, 17
    s_cbranch_scc1 L_w80
    s_waitcnt vmcnt(8)
    s_bitcmp1_b32 s53, 17
    s_cbranch_scc1 L_w80
    s_waitcnt vmcnt(7)
    s_bitcmp1_b32 s52, 17
    s_cbranch_scc1 L_w80
    s_waitcnt vmcnt(5)
L_w80:
    s_xor_b32 s6, s97, 20480
    buffer_load_dwordx4 a[116:119], v2, s[36:39], s6 offen nt
    v_mov_b32 v64, v56
    v_mov_b32 v65, v57
    v_mov_b32 v66, v58
    v_mov_b32 v67, v59
    v_mov_b32 v68, v60
    v_mov_b32 v69, v61
    v_mov_b32 v70, v62
    v_mov_b32 v71, v63
    v_permlane32_swap_b32 v56, v64
    v_permlane32_swap_b32 v57, v65
    v_permlane32_swap_b32 v58, v66
    v_permlane32_swap_b32 v59, v67
    v_permlane32_swap_b32 v60, v68
    v_permlane32_swap_b32 v61, v69
    v_permlane32_swap_b32 v62, v70
    v_permlane32_swap_b32 v63, v71
    v_add_f32 v56, v56, v64
    v_add_f32 v57, v57, v65
    v_add_f32 v58, v58, v66
    v_add_f32 v59, v59, v67
    v_add_f32 v60, v60, v68
    v_add_f32 v61, v61, v69
    v_add_f32 v62, v62, v70
    v_add_f32 v63, v63, v71
    s_waitcnt vmcnt(9)
    s_bitcmp1_b32 s54, 17
    s_cbranch_scc1 L_w81
    s_waitcnt vmcnt(8)
    s_bitcmp1_b32 s53, 17
    s_cbranch_scc1 L_w81
    s_waitcnt vmcnt(6)
    s_bitcmp1_b32 s52, 17
    s_cbranch_scc1 L_w81
    s_waitcnt vmcnt(5)
L_w81:
    s_xor_b32 s6, s97, 24576
    buffer_load_dwordx4 a[120:123], v2, s[36:39], s6 offen nt
    v_mov_b32 v64, v56
    v_mov_b32 v65, v57
    v_mov_b32 v66, v58
    v_mov_b32 v67, v59
    v_mov_b32 v68, v60
    v_mov_b32 v69, v61
    v_mov_b32 v70, v62
    v_mov_b32 v71, v63
    v_permlane16_swap_b32 v56, v64
    v_permlane16_swap_b32 v57, v65
    v_permlane16_swap_b32 v58, v66
    v_permlane16_swap_b32 v59, v67
    v_permlane16_swap_b32 v60, v68
    v_permlane16_swap_b32 v61, v69
    v_permlane16_swap_b32 v62, v70
    v_permlane16_swap_b32 v63, v71
    v_add_f32 v56, v56, v64
    v_add_f32 v57, v57, v65
    v_add_f32 v58, v58, v66
    v_add_f32 v59, v59, v67
    v_add_f32 v60, v60, v68
    v_add_f32 v61, v61, v69
    v_add_f32 v62, v62, v70
    v_add_f32 v63, v63, v71
    v_cvt_pk_bf16_f32 v8, v56, v57
    v_cvt_pk_bf16_f32 v9, v58, v59
    v_cvt_pk_bf16_f32 v10, v60, v61
    v_cvt_pk_bf16_f32 v11, v62, v63
    s_mov_b32 s66, 0xaaaaaaaa
    s_mov_b32 s67, 0xaaaaaaaa
    s_mov_b32 s68, 0xcccccccc
    s_mov_b32 s69, 0xcccccccc
    s_waitcnt vmcnt(9)
    s_bitcmp1_b32 s54, 17
    s_cbranch_scc1 L_w82
    s_waitcnt vmcnt(7)
    s_bitcmp1_b32 s53, 17
    s_cbranch_scc1 L_w82
    s_waitcnt vmcnt(6)
    s_bitcmp1_b32 s52, 17
    s_cbranch_scc1 L_w82
    s_waitcnt vmcnt(4)
L_w82:
    s_xor_b32 s6, s97, 28672
    buffer_load_dwordx4 a[124:127], v2, s[36:39], s6 offen nt
    v_mov_b32 v36, 0
    v_mov_b32 v37, 0
    v_dot2c_f32_bf16 v36, v96, v8
    v_dot2c_f32_bf16 v37, v100, v8
    v_dot2c_f32_bf16 v36, v97, v9
    v_dot2c_f32_bf16 v37, v101, v9
    v_dot2c_f32_bf16 v36, v98, v10
    v_dot2c_f32_bf16 v37, v102, v10
    v_dot2c_f32_bf16 v36, v99, v11
    v_dot2c_f32_bf16 v37, v103, v11
    v_mov_b32 v38, 0
    v_mov_b32 v39, 0
    v_dot2c_f32_bf16 v38, v104, v8
    v_dot2c_f32_bf16 v39, v108, v8
    v_dot2c_f32_bf16 v38, v105, v9
    v_dot2c_f32_bf16 v39, v109, v9
    v_dot2c_f32_bf16 v38, v106, v10
    v_dot2c_f32_bf16 v39, v110, v10
    v_dot2c_f32_bf16 v38, v107, v11
    v_dot2c_f32_bf16 v39, v111, v11
    s_waitcnt vmcnt(8)
    s_bitcmp1_b32 s54, 18
    s_cbranch_scc1 L_w83
    s_waitcnt vmcnt(7)
    s_bitcmp1_b32 s53, 18
    s_cbranch_scc1 L_w83
    s_waitcnt vmcnt(5)
    s_bitcmp1_b32 s52, 18
    s_cbranch_scc1 L_w83
    s_waitcnt vmcnt(4)
L_w83:
    s_xor_b32 s6, s97, 32768
    buffer_load_dwordx4 a[128:131], v2, s[36:39], s6 offen nt
    v_mov_b32 v40, 0
    v_mov_b32 v41, 0
    v_dot2c_f32_bf16 v40, v112, v8
    v_dot2c_f32_bf16 v41, v116, v8
    v_dot2c_f32_bf16 v40, v113, v9
    v_dot2c_f32_bf16 v41, v117, v9
    v_dot2c_f32_bf16 v40, v114, v10
    v_dot2c_f32_bf16 v41, v118, v10
    v_dot2c_f32_bf16 v40, v115, v11
    v_dot2c_f32_bf16 v41, v119, v11
    v_mov_b32 v42, 0
    v_mov_b32 v43, 0
    v_dot2c_f32_bf16 v42, v120, v8
    v_dot2c_f32_bf16 v43, v124, v8
    v_dot2c_f32_bf16 v42, v121, v9
    v_dot2c_f32_bf16 v43, v125, v9
    v_dot2c_f32_bf16 v42, v122, v10
    v_dot2c_f32_bf16 v43, v126, v10
    v_dot2c_f32_bf16 v42, v123, v11
    v_dot2c_f32_bf16 v43, v127, v11
    s_lshr_b32 s8, s13, 2
    s_sub_i32 s8, 88, s8
    v_mov_b32 v73, s8
    s_mov_b64 exec, 1
    global_store_byte v72, v73, s[30:31] offset:256
    s_mov_b64 exec, -1
    s_waitcnt vmcnt(9)
    s_bitcmp1_b32 s54, 18
    s_cbranch_scc1 L_w84
    s_waitcnt vmcnt(7)
    s_bitcmp1_b32 s53, 18
    s_cbranch_scc1 L_w84
    s_waitcnt vmcnt(6)
    s_bitcmp1_b32 s52, 18
    s_cbranch_scc1 L_w84
    s_waitcnt vmcnt(4)
L_w84:
    s_xor_b32 s6, s97, 36864
    buffer_load_dwordx4 a[132:135], v2, s[36:39], s6 offen nt
    v_mov_b32 v44, 0
    v_mov_b32 v45, 0
    v_dot2c_f32_bf16 v44, v128, v8
    v_dot2c_f32_bf16 v45, v132, v8
    v_dot2c_f32_bf16 v44, v129, v9
    v_dot2c_f32_bf16 v45, v133, v9
    v_dot2c_f32_bf16 v44, v130, v10
    v_dot2c_f32_bf16 v45, v134, v10
    v_dot2c_f32_bf16 v44, v131, v11
    v_dot2c_f32_bf16 v45, v135, v11
    v_mov_b32 v46, 0
    v_mov_b32 v47, 0
    v_dot2c_f32_bf16 v46, v136, v8
    v_dot2c_f32_bf16 v47, v140, v8
    v_dot2c_f32_bf16 v46, v137, v9
    v_dot2c_f32_bf16 v47, v141, v9
    v_dot2c_f32_bf16 v46, v138, v10
    v_dot2c_f32_bf16 v47, v142, v10
    v_dot2c_f32_bf16 v46, v139, v11
    v_dot2c_f32_bf16 v47, v143, v11
    s_waitcnt vmcnt(8)
    s_bitcmp1_b32 s54, 18
    s_cbranch_scc1 L_w85
    s_waitcnt vmcnt(7)
    s_bitcmp1_b32 s53, 18
    s_cbranch_scc1 L_w85
    s_waitcnt vmcnt(5)
    s_bitcmp1_b32 s52, 18
    s_cbranch_scc1 L_w85
    s_waitcnt vmcnt(4)
L_w85:
    s_xor_b32 s6, s97, 40960
    buffer_load_dwordx4 a[136:139], v2, s[36:39], s6 offen nt
    v_mov_b32 v48, 0
    v_mov_b32 v49, 0
    v_dot2c_f32_bf16 v48, v144, v8
    v_dot2c_f32_bf16 v49, v148, v8
    v_dot2c_f32_bf16 v48, v145, v9
    v_dot2c_f32_bf16 v49, v149, v9
    v_dot2c_f32_bf16 v48, v146, v10
    v_dot2c_f32_bf16 v49, v150, v10
    v_dot2c_f32_bf16 v48, v147, v11
    v_dot2c_f32_bf16 v49, v151, v11
    v_mov_b32 v50, 0
    v_mov_b32 v51, 0
    v_dot2c_f32_bf16 v50, v152, v8
    v_dot2c_f32_bf16 v51, v156, v8
    v_dot2c_f32_bf16 v50, v153, v9
    v_dot2c_f32_bf16 v51, v157, v9
    v_dot2c_f32_bf16 v50, v154, v10
    v_dot2c_f32_bf16 v51, v158, v10
    v_dot2c_f32_bf16 v50, v155, v11
    v_dot2c_f32_bf16 v51, v159, v11
    v_readlane_b32 s57, v76, 32
    v_sad_u8 v76, v76, 0, 0
    s_nop 1
    v_add_u32_dpp v76, v76, v76 row_ror:8 row_mask:0xf bank_mask:0xf
    s_nop 1
    v_add_u32_dpp v76, v76, v76 row_ror:4 row_mask:0xf bank_mask:0xf
    s_nop 1
    v_add_u32_dpp v76, v76, v76 row_ror:2 row_mask:0xf bank_mask:0xf
    s_nop 1
    v_add_u32_dpp v76, v76, v76 row_ror:1 row_mask:0xf bank_mask:0xf
    s_nop 0
    v_readlane_b32 s8, v76, 0
    v_readlane_b32 s9, v76, 16
    s_add_u32 s8, s8, s9
    s_sub_i32 s8, s56, s8
    s_sub_i32 s8, s8, s57
    s_cmp_lg_u32 s98, 0
    s_cselect_b32 s8, 0, s8
    s_mul_i32 s8, s8, 19
    s_ashr_i32 s8, s8, 10
    s_sub_i32 s13, s1, s8
    s_max_i32 s13, s13, 5
    s_min_i32 s13, s13, 24
    s_and_b32 s58, s13, 7
    s_lshl_b32 s58, s58, 3
    s_lshr_b64 s[58:59], vcc, s58
    s_and_b32 s58, s58, 0xff
    s_mul_i32 s58, s58, 0x01010101
    s_mov_b32 s59, s58
    s_lshr_b64 s[58:59], s[58:59], s0
    s_cmp_ge_u32 s13, 8
    s_cselect_b32 s52, -1, s58
    s_cselect_b32 s53, s58, 0
    s_cmp_ge_u32 s13, 16
    s_cselect_b32 s53, -1, s53
    s_cselect_b32 s54, s58, 0
    s_cmp_ge_u32 s13, 24
    s_cselect_b32 s54, -1, s54
    global_load_dword v74, v89, s[30:31] offset:256 nt
    s_lshr_b32 s8, s13, 2
    s_mul_i32 s8, s8, 80
    s_mul_i32 s9, s12, 74
    s_lshr_b32 s9, s9, 4
    s_add_u32 s8, s8, s9
    s_sub_i32 s10, 7080, s8
    s_waitcnt vmcnt(9)
    s_bitcmp1_b32 s54, 18
    s_cbranch_scc1 L_w86
    s_waitcnt vmcnt(7)
    s_bitcmp1_b32 s53, 18
    s_cbranch_scc1 L_w86
    s_waitcnt vmcnt(6)
    s_bitcmp1_b32 s52, 18
    s_cbranch_scc1 L_w86
    s_waitcnt vmcnt(5)
L_w86:
    s_xor_b32 s6, s97, 45056
    buffer_load_dwordx4 a[140:143], v2, s[36:39], s6 offen nt
    v_add_f32_dpp v36, v36, v36 row_ror:8 row_mask:0xf bank_mask:0x3
    v_add_f32_dpp v37, v37, v37 row_ror:8 row_mask:0xf bank_mask:0x3
    v_add_f32_dpp v38, v38, v38 row_ror:8 row_mask:0xf bank_mask:0x3
    v_add_f32_dpp v39, v39, v39 row_ror:8 row_mask:0xf bank_mask:0x3
    v_add_f32_dpp v40, v40, v40 row_ror:8 row_mask:0xf bank_mask:0x3
    v_add_f32_dpp v41, v41, v41 row_ror:8 row_mask:0xf bank_mask:0x3
    v_add_f32_dpp v42, v42, v42 row_ror:8 row_mask:0xf bank_mask:0x3
    v_add_f32_dpp v43, v43, v43 row_ror:8 row_mask:0xf bank_mask:0x3
    v_add_f32_dpp v36, v44, v44 row_ror:8 row_mask:0xf bank_mask:0xc
    v_add_f32_dpp v37, v45, v45 row_ror:8 row_mask:0xf bank_mask:0xc
    v_add_f32_dpp v38, v46, v46 row_ror:8 row_mask:0xf bank_mask:0xc
    v_add_f32_dpp v39, v47, v47 row_ror:8 row_mask:0xf bank_mask:0xc
    v_add_f32_dpp v40, v48, v48 row_ror:8 row_mask:0xf bank_mask:0xc
    v_add_f32_dpp v41, v49, v49 row_ror:8 row_mask:0xf bank_mask:0xc
    v_add_f32_dpp v42, v50, v50 row_ror:8 row_mask:0xf bank_mask:0xc
    v_add_f32_dpp v43, v51, v51 row_ror:8 row_mask:0xf bank_mask:0xc
    v_add_f32_dpp v36, v36, v36 row_ror:12 row_mask:0xf bank_mask:0x5
    v_add_f32_dpp v37, v37, v37 row_ror:12 row_mask:0xf bank_mask:0x5
    v_add_f32_dpp v38, v38, v38 row_ror:12 row_mask:0xf bank_mask:0x5
    v_add_f32_dpp v39, v39, v39 row_ror:12 row_mask:0xf bank_mask:0x5
    v_add_f32_dpp v36, v40, v40 row_ror:4 row_mask:0xf bank_mask:0xa
    v_add_f32_dpp v37, v41, v41 row_ror:4 row_mask:0xf bank_mask:0xa
    v_add_f32_dpp v38, v42, v42 row_ror:4 row_mask:0xf bank_mask:0xa
    v_add_f32_dpp v39, v43, v43 row_ror:4 row_mask:0xf bank_mask:0xa
    v_add_f32_dpp v36, v36, v36 quad_perm:[1,0,3,2] row_mask:0xf bank_mask:0xf
    v_add_f32_dpp v37, v37, v37 quad_perm:[1,0,3,2] row_mask:0xf bank_mask:0xf
    v_add_f32_dpp v38, v38, v38 quad_perm:[1,0,3,2] row_mask:0xf bank_mask:0xf
    v_add_f32_dpp v39, v39, v39 quad_perm:[1,0,3,2] row_mask:0xf bank_mask:0xf
    v_add_f32_dpp v36, v36, v36 quad_perm:[2,3,0,1] row_mask:0xf bank_mask:0xf
    v_add_f32_dpp v37, v37, v37 quad_perm:[2,3,0,1] row_mask:0xf bank_mask:0xf
    v_add_f32_dpp v38, v38, v38 quad_perm:[2,3,0,1] row_mask:0xf bank_mask:0xf
    v_add_f32_dpp v39, v39, v39 quad_perm:[2,3,0,1] row_mask:0xf bank_mask:0xf
    v_cndmask_b32 v36, v36, v37, s[66:67]
    v_cndmask_b32 v38, v38, v39, s[66:67]
    v_cndmask_b32 v12, v36, v38, s[68:69]
    s_lshr_b32 s14, s2, 3
    s_or_b32 s14, s14, s3
    s_add_u32 s40, s30, 653824
    s_addc_u32 s41, s31, 0
    s_mov_b32 s19, 1
    s_waitcnt vmcnt(8)
    s_bitcmp1_b32 s54, 19
    s_cbranch_scc1 L_w87
    s_waitcnt vmcnt(7)
    s_bitcmp1_b32 s53, 19
    s_cbranch_scc1 L_w87
    s_waitcnt vmcnt(6)
    s_bitcmp1_b32 s52, 19
    s_cbranch_scc1 L_w87
    s_waitcnt vmcnt(5)
L_w87:
    s_xor_b32 s6, s97, 49152
    buffer_load_dwordx4 a[144:147], v2, s[36:39], s6 offen nt
    v_mov_b32 v36, 0
    v_mov_b32 v37, 0
    v_dot2c_f32_bf16 v36, v160, v8
    v_dot2c_f32_bf16 v37, v164, v8
    v_dot2c_f32_bf16 v36, v161, v9
    v_dot2c_f32_bf16 v37, v165, v9
    v_dot2c_f32_bf16 v36, v162, v10
    v_dot2c_f32_bf16 v37, v166, v10
    v_dot2c_f32_bf16 v36, v163, v11
    v_dot2c_f32_bf16 v37, v167, v11
    v_mov_b32 v38, 0
    v_mov_b32 v39, 0
    v_dot2c_f32_bf16 v38, v168, v8
    v_dot2c_f32_bf16 v39, v172, v8
    v_dot2c_f32_bf16 v38, v169, v9
    v_dot2c_f32_bf16 v39, v173, v9
    v_dot2c_f32_bf16 v38, v170, v10
    v_dot2c_f32_bf16 v39, v174, v10
    v_dot2c_f32_bf16 v38, v171, v11
    v_dot2c_f32_bf16 v39, v175, v11
    s_cmp_lg_u32 s14, 0
    s_cbranch_scc1 L_g88
    s_load_dword s42, s[40:41], 0 glc
L_g88:
    s_lshr_b32 s8, s13, 2
    s_sub_i32 s8, 96, s8
    v_mov_b32 v73, s8
    s_mov_b64 exec, 1
    global_store_byte v72, v73, s[30:31] offset:256
    s_mov_b64 exec, -1
    s_waitcnt vmcnt(9)
    s_bitcmp1_b32 s54, 19
    s_cbranch_scc1 L_w89
    s_waitcnt vmcnt(8)
    s_bitcmp1_b32 s53, 19
    s_cbranch_scc1 L_w89
    s_waitcnt vmcnt(7)
    s_bitcmp1_b32 s52, 19
    s_cbranch_scc1 L_w89
    s_waitcnt vmcnt(5)
L_w89:
    s_xor_b32 s6, s97, 53248
    buffer_load_dwordx4 a[148:151], v2, s[36:39], s6 offen nt
    v_mov_b32 v40, 0
    v_mov_b32 v41, 0
    v_dot2c_f32_bf16 v40, v176, v8
    v_dot2c_f32_bf16 v41, v180, v8
    v_dot2c_f32_bf16 v40, v177, v9
    v_dot2c_f32_bf16 v41, v181, v9
    v_dot2c_f32_bf16 v40, v178, v10
    v_dot2c_f32_bf16 v41, v182, v10
    v_dot2c_f32_bf16 v40, v179, v11
    v_dot2c_f32_bf16 v41, v183, v11
    v_mov_b32 v42, 0
    v_mov_b32 v43, 0
    v_dot2c_f32_bf16 v42, v184, v8
    v_dot2c_f32_bf16 v43, v188, v8
    v_dot2c_f32_bf16 v42, v185, v9
    v_dot2c_f32_bf16 v43, v189, v9
    v_dot2c_f32_bf16 v42, v186, v10
    v_dot2c_f32_bf16 v43, v190, v10
    v_dot2c_f32_bf16 v42, v187, v11
    v_dot2c_f32_bf16 v43, v191, v11
    s_waitcnt vmcnt(9)
    s_bitcmp1_b32 s54, 19
    s_cbranch_scc1 L_w90
    s_waitcnt vmcnt(8)
    s_bitcmp1_b32 s53, 19
    s_cbranch_scc1 L_w90
    s_waitcnt vmcnt(6)
    s_bitcmp1_b32 s52, 19
    s_cbranch_scc1 L_w90
    s_waitcnt vmcnt(5)
L_w90:
    s_xor_b32 s6, s97, 57344
    buffer_load_dwordx4 a[152:155], v2, s[36:39], s6 offen nt
    v_mov_b32 v44, 0
    v_mov_b32 v45, 0
    v_dot2c_f32_bf16 v44, v192, v8
    v_dot2c_f32_bf16 v45, v196, v8
    v_dot2c_f32_bf16 v44, v193, v9
    v_dot2c_f32_bf16 v45, v197, v9
    v_dot2c_f32_bf16 v44, v194, v10
    v_dot2c_f32_bf16 v45, v198, v10
    v_dot2c_f32_bf16 v44, v195, v11
    v_dot2c_f32_bf16 v45, v199, v11
    v_mov_b32 v46, 0
    v_mov_b32 v47, 0
    v_dot2c_f32_bf16 v46, v200, v8
    v_dot2c_f32_bf16 v47, v204, v8
    v_dot2c_f32_bf16 v46, v201, v9
    v_dot2c_f32_bf16 v47, v205, v9
    v_dot2c_f32_bf16 v46, v202, v10
    v_dot2c_f32_bf16 v47, v206, v10
    v_dot2c_f32_bf16 v46, v203, v11
    v_dot2c_f32_bf16 v47, v207, v11
    s_waitcnt vmcnt(9)
    s_bitcmp1_b32 s54, 19
    s_cbranch_scc1 L_w91
    s_waitcnt vmcnt(7)
    s_bitcmp1_b32 s53, 19
    s_cbranch_scc1 L_w91
    s_waitcnt vmcnt(6)
    s_bitcmp1_b32 s52, 19
    s_cbranch_scc1 L_w91
    s_waitcnt vmcnt(4)
L_w91:
    s_xor_b32 s6, s97, 61440
    buffer_load_dwordx4 a[156:159], v2, s[36:39], s6 offen nt
    v_mov_b32 v48, 0
    v_mov_b32 v49, 0
    v_dot2c_f32_bf16 v48, v208, v8
    v_dot2c_f32_bf16 v49, v212, v8
    v_dot2c_f32_bf16 v48, v209, v9
    v_dot2c_f32_bf16 v49, v213, v9
    v_dot2c_f32_bf16 v48, v210, v10
    v_dot2c_f32_bf16 v49, v214, v10
    v_dot2c_f32_bf16 v48, v211, v11
    v_dot2c_f32_bf16 v49, v215, v11
    v_mov_b32 v50, 0
    v_mov_b32 v51, 0
    v_dot2c_f32_bf16 v50, v216, v8
    v_dot2c_f32_bf16 v51, v220, v8
    v_dot2c_f32_bf16 v50, v217, v9
    v_dot2c_f32_bf16 v51, v221, v9
    v_dot2c_f32_bf16 v50, v218, v10
    v_dot2c_f32_bf16 v51, v222, v10
    v_dot2c_f32_bf16 v50, v219, v11
    v_dot2c_f32_bf16 v51, v223, v11
    s_waitcnt vmcnt(8)
    s_bitcmp1_b32 s54, 20
    s_cbranch_scc1 L_w92
    s_waitcnt vmcnt(7)
    s_bitcmp1_b32 s53, 20
    s_cbranch_scc1 L_w92
    s_waitcnt vmcnt(5)
    s_bitcmp1_b32 s52, 20
    s_cbranch_scc1 L_w92
    s_waitcnt vmcnt(4)
L_w92:
    s_xor_b32 s6, s97, 65536
    buffer_load_dwordx4 a[160:163], v2, s[36:39], s6 offen nt
    v_add_f32_dpp v36, v36, v36 row_ror:8 row_mask:0xf bank_mask:0x3
    v_add_f32_dpp v37, v37, v37 row_ror:8 row_mask:0xf bank_mask:0x3
    v_add_f32_dpp v38, v38, v38 row_ror:8 row_mask:0xf bank_mask:0x3
    v_add_f32_dpp v39, v39, v39 row_ror:8 row_mask:0xf bank_mask:0x3
    v_add_f32_dpp v40, v40, v40 row_ror:8 row_mask:0xf bank_mask:0x3
    v_add_f32_dpp v41, v41, v41 row_ror:8 row_mask:0xf bank_mask:0x3
    v_add_f32_dpp v42, v42, v42 row_ror:8 row_mask:0xf bank_mask:0x3
    v_add_f32_dpp v43, v43, v43 row_ror:8 row_mask:0xf bank_mask:0x3
    v_add_f32_dpp v36, v44, v44 row_ror:8 row_mask:0xf bank_mask:0xc
    v_add_f32_dpp v37, v45, v45 row_ror:8 row_mask:0xf bank_mask:0xc
    v_add_f32_dpp v38, v46, v46 row_ror:8 row_mask:0xf bank_mask:0xc
    v_add_f32_dpp v39, v47, v47 row_ror:8 row_mask:0xf bank_mask:0xc
    v_add_f32_dpp v40, v48, v48 row_ror:8 row_mask:0xf bank_mask:0xc
    v_add_f32_dpp v41, v49, v49 row_ror:8 row_mask:0xf bank_mask:0xc
    v_add_f32_dpp v42, v50, v50 row_ror:8 row_mask:0xf bank_mask:0xc
    v_add_f32_dpp v43, v51, v51 row_ror:8 row_mask:0xf bank_mask:0xc
    v_add_f32_dpp v36, v36, v36 row_ror:12 row_mask:0xf bank_mask:0x5
    v_add_f32_dpp v37, v37, v37 row_ror:12 row_mask:0xf bank_mask:0x5
    v_add_f32_dpp v38, v38, v38 row_ror:12 row_mask:0xf bank_mask:0x5
    v_add_f32_dpp v39, v39, v39 row_ror:12 row_mask:0xf bank_mask:0x5
    v_add_f32_dpp v36, v40, v40 row_ror:4 row_mask:0xf bank_mask:0xa
    v_add_f32_dpp v37, v41, v41 row_ror:4 row_mask:0xf bank_mask:0xa
    v_add_f32_dpp v38, v42, v42 row_ror:4 row_mask:0xf bank_mask:0xa
    v_add_f32_dpp v39, v43, v43 row_ror:4 row_mask:0xf bank_mask:0xa
    v_add_f32_dpp v36, v36, v36 quad_perm:[1,0,3,2] row_mask:0xf bank_mask:0xf
    v_add_f32_dpp v37, v37, v37 quad_perm:[1,0,3,2] row_mask:0xf bank_mask:0xf
    v_add_f32_dpp v38, v38, v38 quad_perm:[1,0,3,2] row_mask:0xf bank_mask:0xf
    v_add_f32_dpp v39, v39, v39 quad_perm:[1,0,3,2] row_mask:0xf bank_mask:0xf
    v_add_f32_dpp v36, v36, v36 quad_perm:[2,3,0,1] row_mask:0xf bank_mask:0xf
    v_add_f32_dpp v37, v37, v37 quad_perm:[2,3,0,1] row_mask:0xf bank_mask:0xf
    v_add_f32_dpp v38, v38, v38 quad_perm:[2,3,0,1] row_mask:0xf bank_mask:0xf
    v_add_f32_dpp v39, v39, v39 quad_perm:[2,3,0,1] row_mask:0xf bank_mask:0xf
    v_cndmask_b32 v36, v36, v37, s[66:67]
    v_cndmask_b32 v38, v38, v39, s[66:67]
    v_cndmask_b32 v13, v36, v38, s[68:69]
    s_cmp_lg_u32 s14, 0
    s_cbranch_scc1 L_g93
    s_atomic_add s19, s[40:41], 0
    s_load_dword s43, s[40:41], 0 glc
L_g93:
    s_lshr_b32 s8, s13, 2
    s_sub_i32 s8, 104, s8
    v_mov_b32 v73, s8
    s_mov_b64 exec, 1
    global_store_byte v72, v73, s[30:31] offset:256
    s_mov_b64 exec, -1
    s_waitcnt vmcnt(9)
    s_bitcmp1_b32 s54, 20
    s_cbranch_scc1 L_w94
    s_waitcnt vmcnt(7)
    s_bitcmp1_b32 s53, 20
    s_cbranch_scc1 L_w94
    s_waitcnt vmcnt(6)
    s_bitcmp1_b32 s52, 20
    s_cbranch_scc1 L_w94
    s_waitcnt vmcnt(4)
L_w94:
    s_xor_b32 s6, s97, 69632
    buffer_load_dwordx4 a[164:167], v2, s[36:39], s6 offen nt
    v_mov_b32 v36, 0
    v_mov_b32 v37, 0
    v_dot2c_f32_bf16 v36, v224, v8
    v_dot2c_f32_bf16 v37, v228, v8
    v_dot2c_f32_bf16 v36, v225, v9
    v_dot2c_f32_bf16 v37, v229, v9
    v_dot2c_f32_bf16 v36, v226, v10
    v_dot2c_f32_bf16 v37, v230, v10
    v_dot2c_f32_bf16 v36, v227, v11
    v_dot2c_f32_bf16 v37, v231, v11
    s_waitcnt vmcnt(8)
    s_bitcmp1_b32 s54, 20
    s_cbranch_scc1 L_w95
    s_waitcnt vmcnt(7)
    s_bitcmp1_b32 s53, 20
    s_cbranch_scc1 L_w95
    s_waitcnt vmcnt(5)
    s_bitcmp1_b32 s52, 20
    s_cbranch_scc1 L_w95
    s_waitcnt vmcnt(4)
L_w95:
    s_xor_b32 s6, s97, 73728
    buffer_load_dwordx4 a[168:171], v2, s[36:39], s6 offen nt
    v_mov_b32 v38, 0
    v_mov_b32 v39, 0
    v_dot2c_f32_bf16 v38, v232, v8
    v_dot2c_f32_bf16 v39, v236, v8
    v_dot2c_f32_bf16 v38, v233, v9
    v_dot2c_f32_bf16 v39, v237, v9
    v_dot2c_f32_bf16 v38, v234, v10
    v_dot2c_f32_bf16 v39, v238, v10
    v_dot2c_f32_bf16 v38, v235, v11
    v_dot2c_f32_bf16 v39, v239, v11
    v_readlane_b32 s57, v74, 32
    v_sad_u8 v74, v74, 0, 0
    s_nop 1
    v_add_u32_dpp v74, v74, v74 row_ror:8 row_mask:0xf bank_mask:0xf
    s_nop 1
    v_add_u32_dpp v74, v74, v74 row_ror:4 row_mask:0xf bank_mask:0xf
    s_nop 1
    v_add_u32_dpp v74, v74, v74 row_ror:2 row_mask:0xf bank_mask:0xf
    s_nop 1
    v_add_u32_dpp v74, v74, v74 row_ror:1 row_mask:0xf bank_mask:0xf
    s_nop 0
    v_readlane_b32 s8, v74, 0
    v_readlane_b32 s9, v74, 16
    s_add_u32 s8, s8, s9
    s_sub_i32 s8, s10, s8
    s_sub_i32 s8, s8, s57
    s_cmp_lg_u32 s98, 0
    s_cselect_b32 s8, 0, s8
    s_mul_i32 s8, s8, 19
    s_ashr_i32 s8, s8, 10
    s_sub_i32 s13, s1, s8
    s_max_i32 s13, s13, 5
    s_min_i32 s13, s13, 24
    s_and_b32 s58, s13, 7
    s_lshl_b32 s58, s58, 3
    s_lshr_b64 s[58:59], vcc, s58
    s_and_b32 s58, s58, 0xff
    s_mul_i32 s58, s58, 0x01010101
    s_mov_b32 s59, s58
    s_lshr_b64 s[58:59], s[58:59], s0
    s_cmp_ge_u32 s13, 8
    s_cselect_b32 s52, -1, s58
    s_cselect_b32 s53, s58, 0
    s_cmp_ge_u32 s13, 16
    s_cselect_b32 s53, -1, s53
    s_cselect_b32 s54, s58, 0
    s_cmp_ge_u32 s13, 24
    s_cselect_b32 s54, -1, s54
    global_load_dword v75, v89, s[30:31] offset:256 nt
    s_lshr_b32 s8, s13, 2
    s_mul_i32 s8, s8, 80
    s_mul_i32 s9, s12, 82
    s_lshr_b32 s9, s9, 4
    s_add_u32 s8, s8, s9
    s_sub_i32 s11, 8360, s8
    s_waitcnt vmcnt(9)
    s_bitcmp1_b32 s54, 20
    s_cbranch_scc1 L_w96
    s_waitcnt vmcnt(7)
    s_bitcmp1_b32 s53, 20
    s_cbranch_scc1 L_w96
    s_waitcnt vmcnt(6)
    s_bitcmp1_b32 s52, 20
    s_cbranch_scc1 L_w96
    s_waitcnt vmcnt(5)
L_w96:
    s_xor_b32 s6, s97, 77824
    buffer_load_dwordx4 a[172:175], v2, s[36:39], s6 offen nt
    v_mov_b32 v40, 0
    v_mov_b32 v41, 0
    v_dot2c_f32_bf16 v40, v240, v8
    v_dot2c_f32_bf16 v41, v244, v8
    v_dot2c_f32_bf16 v40, v241, v9
    v_dot2c_f32_bf16 v41, v245, v9
    v_dot2c_f32_bf16 v40, v242, v10
    v_dot2c_f32_bf16 v41, v246, v10
    v_dot2c_f32_bf16 v40, v243, v11
    v_dot2c_f32_bf16 v41, v247, v11
    s_waitcnt vmcnt(8)
    s_bitcmp1_b32 s54, 21
    s_cbranch_scc1 L_w97
    s_waitcnt vmcnt(7)
    s_bitcmp1_b32 s53, 21
    s_cbranch_scc1 L_w97
    s_waitcnt vmcnt(6)
    s_bitcmp1_b32 s52, 21
    s_cbranch_scc1 L_w97
    s_waitcnt vmcnt(5)
L_w97:
    s_xor_b32 s6, s97, 81920
    buffer_load_dwordx4 a[176:179], v2, s[36:39], s6 offen nt
    v_mov_b32 v42, 0
    v_mov_b32 v43, 0
    v_dot2c_f32_bf16 v42, v248, v8
    v_dot2c_f32_bf16 v43, v252, v8
    v_dot2c_f32_bf16 v42, v249, v9
    v_dot2c_f32_bf16 v43, v253, v9
    v_dot2c_f32_bf16 v42, v250, v10
    v_dot2c_f32_bf16 v43, v254, v10
    v_dot2c_f32_bf16 v42, v251, v11
    v_dot2c_f32_bf16 v43, v255, v11
    s_cmp_lg_u32 s14, 0
    s_cbranch_scc1 L_g98
    s_load_dword s18, s[40:41], 0 glc
L_g98:
    s_lshr_b32 s8, s13, 2
    s_sub_i32 s8, 112, s8
    v_mov_b32 v73, s8
    s_mov_b64 exec, 1
    global_store_byte v72, v73, s[30:31] offset:256
    s_mov_b64 exec, -1
    s_waitcnt vmcnt(9)
    s_bitcmp1_b32 s54, 21
    s_cbranch_scc1 L_w99
    s_waitcnt vmcnt(8)
    s_bitcmp1_b32 s53, 21
    s_cbranch_scc1 L_w99
    s_waitcnt vmcnt(7)
    s_bitcmp1_b32 s52, 21
    s_cbranch_scc1 L_w99
    s_waitcnt vmcnt(5)
L_w99:
    s_xor_b32 s6, s97, 86016
    buffer_load_dwordx4 a[180:183], v2, s[36:39], s6 offen nt
    v_accvgpr_read_b32 v28, a0
    v_accvgpr_read_b32 v29, a1
    v_accvgpr_read_b32 v30, a2
    v_accvgpr_read_b32 v31, a3
    v_mov_b32 v44, 0
    v_accvgpr_read_b32 v32, a4
    v_accvgpr_read_b32 v33, a5
    v_accvgpr_read_b32 v34, a6
    v_accvgpr_read_b32 v35, a7
    v_mov_b32 v45, 0
    v_dot2c_f32_bf16 v44, v28, v8
    v_dot2c_f32_bf16 v45, v32, v8
    v_dot2c_f32_bf16 v44, v29, v9
    v_dot2c_f32_bf16 v45, v33, v9
    v_dot2c_f32_bf16 v44, v30, v10
    v_dot2c_f32_bf16 v45, v34, v10
    v_dot2c_f32_bf16 v44, v31, v11
    v_dot2c_f32_bf16 v45, v35, v11
    s_waitcnt vmcnt(9)
    s_bitcmp1_b32 s54, 21
    s_cbranch_scc1 L_w100
    s_waitcnt vmcnt(8)
    s_bitcmp1_b32 s53, 21
    s_cbranch_scc1 L_w100
    s_waitcnt vmcnt(6)
    s_bitcmp1_b32 s52, 21
    s_cbranch_scc1 L_w100
    s_waitcnt vmcnt(5)
L_w100:
    s_xor_b32 s6, s97, 90112
    buffer_load_dwordx4 a[184:187], v2, s[36:39], s6 offen nt
    v_accvgpr_read_b32 v28, a8
    v_accvgpr_read_b32 v29, a9
    v_accvgpr_read_b32 v30, a10
    v_accvgpr_read_b32 v31, a11
    v_mov_b32 v46, 0
    v_accvgpr_read_b32 v32, a12
    v_accvgpr_read_b32 v33, a13
    v_accvgpr_read_b32 v34, a14
    v_accvgpr_read_b32 v35, a15
    v_mov_b32 v47, 0
    v_dot2c_f32_bf16 v46, v28, v8
    v_dot2c_f32_bf16 v47, v32, v8
    v_dot2c_f32_bf16 v46, v29, v9
    v_dot2c_f32_bf16 v47, v33, v9
    v_dot2c_f32_bf16 v46, v30, v10
    v_dot2c_f32_bf16 v47, v34, v10
    v_dot2c_f32_bf16 v46, v31, v11
    v_dot2c_f32_bf16 v47, v35, v11
    s_waitcnt vmcnt(9)
    s_bitcmp1_b32 s54, 21
    s_cbranch_scc1 L_w101
    s_waitcnt vmcnt(7)
    s_bitcmp1_b32 s53, 21
    s_cbranch_scc1 L_w101
    s_waitcnt vmcnt(6)
    s_bitcmp1_b32 s52, 21
    s_cbranch_scc1 L_w101
    s_waitcnt vmcnt(4)
L_w101:
    s_xor_b32 s6, s97, 94208
    buffer_load_dwordx4 a[188:191], v2, s[36:39], s6 offen nt
    v_accvgpr_read_b32 v28, a16
    v_accvgpr_read_b32 v29, a17
    v_accvgpr_read_b32 v30, a18
    v_accvgpr_read_b32 v31, a19
    v_mov_b32 v48, 0
    v_accvgpr_read_b32 v32, a20
    v_accvgpr_read_b32 v33, a21
    v_accvgpr_read_b32 v34, a22
    v_accvgpr_read_b32 v35, a23
    v_mov_b32 v49, 0
    v_dot2c_f32_bf16 v48, v28, v8
    v_dot2c_f32_bf16 v49, v32, v8
    v_dot2c_f32_bf16 v48, v29, v9
    v_dot2c_f32_bf16 v49, v33, v9
    v_dot2c_f32_bf16 v48, v30, v10
    v_dot2c_f32_bf16 v49, v34, v10
    v_dot2c_f32_bf16 v48, v31, v11
    v_dot2c_f32_bf16 v49, v35, v11
    s_waitcnt vmcnt(8)
    s_bitcmp1_b32 s54, 22
    s_cbranch_scc1 L_w102
    s_waitcnt vmcnt(7)
    s_bitcmp1_b32 s53, 22
    s_cbranch_scc1 L_w102
    s_waitcnt vmcnt(5)
    s_bitcmp1_b32 s52, 22
    s_cbranch_scc1 L_w102
    s_waitcnt vmcnt(4)
L_w102:
    s_xor_b32 s6, s97, 98304
    buffer_load_dwordx4 a[192:195], v2, s[36:39], s6 offen nt
    v_accvgpr_read_b32 v28, a24
    v_accvgpr_read_b32 v29, a25
    v_accvgpr_read_b32 v30, a26
    v_accvgpr_read_b32 v31, a27
    v_mov_b32 v50, 0
    v_accvgpr_read_b32 v32, a28
    v_accvgpr_read_b32 v33, a29
    v_accvgpr_read_b32 v34, a30
    v_accvgpr_read_b32 v35, a31
    v_mov_b32 v51, 0
    v_dot2c_f32_bf16 v50, v28, v8
    v_dot2c_f32_bf16 v51, v32, v8
    v_dot2c_f32_bf16 v50, v29, v9
    v_dot2c_f32_bf16 v51, v33, v9
    v_dot2c_f32_bf16 v50, v30, v10
    v_dot2c_f32_bf16 v51, v34, v10
    v_dot2c_f32_bf16 v50, v31, v11
    v_dot2c_f32_bf16 v51, v35, v11
    s_cmp_lg_u32 s14, 0
    s_cbranch_scc1 L_g103
    s_waitcnt lgkmcnt(0)
    s_add_u32 s42, s42, s43
    s_add_u32 s42, s42, s18
    s_sub_i32 s42, s42, 12
    s_mul_i32 s42, s42, 64
    v_mov_b32 v73, s42
    s_mov_b64 exec, 1
    global_store_dword v89, v73, s[30:31] offset:384
    s_mov_b64 exec, -1
L_g103:
    s_lshr_b32 s8, s13, 2
    s_sub_i32 s8, 120, s8
    v_mov_b32 v73, s8
    s_mov_b64 exec, 1
    global_store_byte v72, v73, s[30:31] offset:256
    s_mov_b64 exec, -1
    s_waitcnt vmcnt(9)
    s_bitcmp1_b32 s54, 22
    s_cbranch_scc1 L_w104
    s_waitcnt vmcnt(7)
    s_bitcmp1_b32 s53, 22
    s_cbranch_scc1 L_w104
    s_waitcnt vmcnt(6)
    s_bitcmp1_b32 s52, 22
    s_cbranch_scc1 L_w104
    s_waitcnt vmcnt(4)
L_w104:
    s_xor_b32 s6, s97, 102400
    buffer_load_dwordx4 a[196:199], v2, s[36:39], s6 offen nt
    v_add_f32_dpp v36, v36, v36 row_ror:8 row_mask:0xf bank_mask:0x3
    v_add_f32_dpp v37, v37, v37 row_ror:8 row_mask:0xf bank_mask:0x3
    v_add_f32_dpp v38, v38, v38 row_ror:8 row_mask:0xf bank_mask:0x3
    v_add_f32_dpp v39, v39, v39 row_ror:8 row_mask:0xf bank_mask:0x3
    v_add_f32_dpp v40, v40, v40 row_ror:8 row_mask:0xf bank_mask:0x3
    v_add_f32_dpp v41, v41, v41 row_ror:8 row_mask:0xf bank_mask:0x3
    v_add_f32_dpp v42, v42, v42 row_ror:8 row_mask:0xf bank_mask:0x3
    v_add_f32_dpp v43, v43, v43 row_ror:8 row_mask:0xf bank_mask:0x3
    v_add_f32_dpp v36, v44, v44 row_ror:8 row_mask:0xf bank_mask:0xc
    v_add_f32_dpp v37, v45, v45 row_ror:8 row_mask:0xf bank_mask:0xc
    v_add_f32_dpp v38, v46, v46 row_ror:8 row_mask:0xf bank_mask:0xc
    v_add_f32_dpp v39, v47, v47 row_ror:8 row_mask:0xf bank_mask:0xc
    v_add_f32_dpp v40, v48, v48 row_ror:8 row_mask:0xf bank_mask:0xc
    v_add_f32_dpp v41, v49, v49 row_ror:8 row_mask:0xf bank_mask:0xc
    v_add_f32_dpp v42, v50, v50 row_ror:8 row_mask:0xf bank_mask:0xc
    v_add_f32_dpp v43, v51, v51 row_ror:8 row_mask:0xf bank_mask:0xc
    v_add_f32_dpp v36, v36, v36 row_ror:12 row_mask:0xf bank_mask:0x5
    v_add_f32_dpp v37, v37, v37 row_ror:12 row_mask:0xf bank_mask:0x5
    v_add_f32_dpp v38, v38, v38 row_ror:12 row_mask:0xf bank_mask:0x5
    v_add_f32_dpp v39, v39, v39 row_ror:12 row_mask:0xf bank_mask:0x5
    v_add_f32_dpp v36, v40, v40 row_ror:4 row_mask:0xf bank_mask:0xa
    v_add_f32_dpp v37, v41, v41 row_ror:4 row_mask:0xf bank_mask:0xa
    v_add_f32_dpp v38, v42, v42 row_ror:4 row_mask:0xf bank_mask:0xa
    v_add_f32_dpp v39, v43, v43 row_ror:4 row_mask:0xf bank_mask:0xa
    v_add_f32_dpp v36, v36, v36 quad_perm:[1,0,3,2] row_mask:0xf bank_mask:0xf
    v_add_f32_dpp v37, v37, v37 quad_perm:[1,0,3,2] row_mask:0xf bank_mask:0xf
    v_add_f32_dpp v38, v38, v38 quad_perm:[1,0,3,2] row_mask:0xf bank_mask:0xf
    v_add_f32_dpp v39, v39, v39 quad_perm:[1,0,3,2] row_mask:0xf bank_mask:0xf
    v_add_f32_dpp v36, v36, v36 quad_perm:[2,3,0,1] row_mask:0xf bank_mask:0xf
    v_add_f32_dpp v37, v37, v37 quad_perm:[2,3,0,1] row_mask:0xf bank_mask:0xf
    v_add_f32_dpp v38, v38, v38 quad_perm:[2,3,0,1] row_mask:0xf bank_mask:0xf
    v_add_f32_dpp v39, v39, v39 quad_perm:[2,3,0,1] row_mask:0xf bank_mask:0xf
    v_cndmask_b32 v36, v36, v37, s[66:67]
    v_cndmask_b32 v38, v38, v39, s[66:67]
    v_cndmask_b32 v14, v36, v38, s[68:69]
    s_waitcnt vmcnt(8)
    s_bitcmp1_b32 s54, 22
    s_cbranch_scc1 L_w105
    s_waitcnt vmcnt(7)
    s_bitcmp1_b32 s53, 22
    s_cbranch_scc1 L_w105
    s_waitcnt vmcnt(5)
    s_bitcmp1_b32 s52, 22
    s_cbranch_scc1 L_w105
    s_waitcnt vmcnt(4)
L_w105:
    s_xor_b32 s6, s97, 106496
    buffer_load_dwordx4 a[200:203], v2, s[36:39], s6 offen nt
    v_accvgpr_read_b32 v28, a32
    v_accvgpr_read_b32 v29, a33
    v_accvgpr_read_b32 v30, a34
    v_accvgpr_read_b32 v31, a35
    v_mov_b32 v36, 0
    v_accvgpr_read_b32 v32, a36
    v_accvgpr_read_b32 v33, a37
    v_accvgpr_read_b32 v34, a38
    v_accvgpr_read_b32 v35, a39
    v_mov_b32 v37, 0
    v_dot2c_f32_bf16 v36, v28, v8
    v_dot2c_f32_bf16 v37, v32, v8
    v_dot2c_f32_bf16 v36, v29, v9
    v_dot2c_f32_bf16 v37, v33, v9
    v_dot2c_f32_bf16 v36, v30, v10
    v_dot2c_f32_bf16 v37, v34, v10
    v_dot2c_f32_bf16 v36, v31, v11
    v_dot2c_f32_bf16 v37, v35, v11
    v_readlane_b32 s57, v75, 32
    v_sad_u8 v75, v75, 0, 0
    s_nop 1
    v_add_u32_dpp v75, v75, v75 row_ror:8 row_mask:0xf bank_mask:0xf
    s_nop 1
    v_add_u32_dpp v75, v75, v75 row_ror:4 row_mask:0xf bank_mask:0xf
    s_nop 1
    v_add_u32_dpp v75, v75, v75 row_ror:2 row_mask:0xf bank_mask:0xf
    s_nop 1
    v_add_u32_dpp v75, v75, v75 row_ror:1 row_mask:0xf bank_mask:0xf
    s_nop 0
    v_readlane_b32 s8, v75, 0
    v_readlane_b32 s9, v75, 16
    s_add_u32 s8, s8, s9
    s_sub_i32 s8, s11, s8
    s_sub_i32 s8, s8, s57
    s_cmp_lg_u32 s98, 0
    s_cselect_b32 s8, 0, s8
    s_mul_i32 s8, s8, 19
    s_ashr_i32 s8, s8, 10
    s_sub_i32 s13, s1, s8
    s_max_i32 s13, s13, 5
    s_min_i32 s13, s13, 24
    s_and_b32 s58, s13, 7
    s_lshl_b32 s58, s58, 3
    s_lshr_b64 s[58:59], vcc, s58
    s_and_b32 s58, s58, 0xff
    s_mul_i32 s58, s58, 0x01010101
    s_mov_b32 s59, s58
    s_lshr_b64 s[58:59], s[58:59], s0
    s_cmp_ge_u32 s13, 8
    s_cselect_b32 s52, -1, s58
    s_cselect_b32 s53, s58, 0
    s_cmp_ge_u32 s13, 16
    s_cselect_b32 s53, -1, s53
    s_cselect_b32 s54, s58, 0
    s_cmp_ge_u32 s13, 24
    s_cselect_b32 s54, -1, s54
    global_load_dword v76, v89, s[30:31] offset:256 nt
    s_lshr_b32 s8, s13, 2
    s_mul_i32 s8, s8, 80
    s_mul_i32 s9, s12, 90
    s_lshr_b32 s9, s9, 4
    s_add_u32 s8, s8, s9
    s_sub_i32 s56, 9640, s8
    s_waitcnt vmcnt(9)
    s_bitcmp1_b32 s54, 22
    s_cbranch_scc1 L_w106
    s_waitcnt vmcnt(7)
    s_bitcmp1_b32 s53, 22
    s_cbranch_scc1 L_w106
    s_waitcnt vmcnt(6)
    s_bitcmp1_b32 s52, 22
    s_cbranch_scc1 L_w106
    s_waitcnt vmcnt(5)
L_w106:
    s_xor_b32 s6, s97, 110592
    buffer_load_dwordx4 a[204:207], v2, s[36:39], s6 offen nt
    v_accvgpr_read_b32 v28, a40
    v_accvgpr_read_b32 v29, a41
    v_accvgpr_read_b32 v30, a42
    v_accvgpr_read_b32 v31, a43
    v_mov_b32 v38, 0
    v_accvgpr_read_b32 v32, a44
    v_accvgpr_read_b32 v33, a45
    v_accvgpr_read_b32 v34, a46
    v_accvgpr_read_b32 v35, a47
    v_mov_b32 v39, 0
    v_dot2c_f32_bf16 v38, v28, v8
    v_dot2c_f32_bf16 v39, v32, v8
    v_dot2c_f32_bf16 v38, v29, v9
    v_dot2c_f32_bf16 v39, v33, v9
    v_dot2c_f32_bf16 v38, v30, v10
    v_dot2c_f32_bf16 v39, v34, v10
    v_dot2c_f32_bf16 v38, v31, v11
    v_dot2c_f32_bf16 v39, v35, v11
    s_waitcnt vmcnt(8)
    s_bitcmp1_b32 s54, 23
    s_cbranch_scc1 L_w107
    s_waitcnt vmcnt(7)
    s_bitcmp1_b32 s53, 23
    s_cbranch_scc1 L_w107
    s_waitcnt vmcnt(6)
    s_bitcmp1_b32 s52, 23
    s_cbranch_scc1 L_w107
    s_waitcnt vmcnt(5)
L_w107:
    s_xor_b32 s6, s97, 114688
    buffer_load_dwordx4 a[208:211], v2, s[36:39], s6 offen nt
    v_accvgpr_read_b32 v28, a48
    v_accvgpr_read_b32 v29, a49
    v_accvgpr_read_b32 v30, a50
    v_accvgpr_read_b32 v31, a51
    v_mov_b32 v40, 0
    v_accvgpr_read_b32 v32, a52
    v_accvgpr_read_b32 v33, a53
    v_accvgpr_read_b32 v34, a54
    v_accvgpr_read_b32 v35, a55
    v_mov_b32 v41, 0
    v_dot2c_f32_bf16 v40, v28, v8
    v_dot2c_f32_bf16 v41, v32, v8
    v_dot2c_f32_bf16 v40, v29, v9
    v_dot2c_f32_bf16 v41, v33, v9
    v_dot2c_f32_bf16 v40, v30, v10
    v_dot2c_f32_bf16 v41, v34, v10
    v_dot2c_f32_bf16 v40, v31, v11
    v_dot2c_f32_bf16 v41, v35, v11
    s_lshr_b32 s8, s13, 2
    s_sub_i32 s8, 128, s8
    v_mov_b32 v73, s8
    s_mov_b64 exec, 1
    global_store_byte v72, v73, s[30:31] offset:256
    s_mov_b64 exec, -1
    s_waitcnt vmcnt(9)
    s_bitcmp1_b32 s54, 23
    s_cbranch_scc1 L_w108
    s_waitcnt vmcnt(8)
    s_bitcmp1_b32 s53, 23
    s_cbranch_scc1 L_w108
    s_waitcnt vmcnt(7)
    s_bitcmp1_b32 s52, 23
    s_cbranch_scc1 L_w108
    s_waitcnt vmcnt(5)
L_w108:
    s_xor_b32 s6, s97, 118784
    buffer_load_dwordx4 a[212:215], v2, s[36:39], s6 offen nt
    v_accvgpr_read_b32 v28, a56
    v_accvgpr_read_b32 v29, a57
    v_accvgpr_read_b32 v30, a58
    v_accvgpr_read_b32 v31, a59
    v_mov_b32 v42, 0
    v_accvgpr_read_b32 v32, a60
    v_accvgpr_read_b32 v33, a61
    v_accvgpr_read_b32 v34, a62
    v_accvgpr_read_b32 v35, a63
    v_mov_b32 v43, 0
    v_dot2c_f32_bf16 v42, v28, v8
    v_dot2c_f32_bf16 v43, v32, v8
    v_dot2c_f32_bf16 v42, v29, v9
    v_dot2c_f32_bf16 v43, v33, v9
    v_dot2c_f32_bf16 v42, v30, v10
    v_dot2c_f32_bf16 v43, v34, v10
    v_dot2c_f32_bf16 v42, v31, v11
    v_dot2c_f32_bf16 v43, v35, v11
    s_waitcnt vmcnt(9)
    s_bitcmp1_b32 s54, 23
    s_cbranch_scc1 L_w109
    s_waitcnt vmcnt(8)
    s_bitcmp1_b32 s53, 23
    s_cbranch_scc1 L_w109
    s_waitcnt vmcnt(6)
    s_bitcmp1_b32 s52, 23
    s_cbranch_scc1 L_w109
    s_waitcnt vmcnt(5)
L_w109:
    s_xor_b32 s6, s97, 122880
    buffer_load_dwordx4 a[216:219], v2, s[36:39], s6 offen nt
    v_accvgpr_read_b32 v28, a64
    v_accvgpr_read_b32 v29, a65
    v_accvgpr_read_b32 v30, a66
    v_accvgpr_read_b32 v31, a67
    v_mov_b32 v44, 0
    v_accvgpr_read_b32 v32, a68
    v_accvgpr_read_b32 v33, a69
    v_accvgpr_read_b32 v34, a70
    v_accvgpr_read_b32 v35, a71
    v_mov_b32 v45, 0
    v_dot2c_f32_bf16 v44, v28, v8
    v_dot2c_f32_bf16 v45, v32, v8
    v_dot2c_f32_bf16 v44, v29, v9
    v_dot2c_f32_bf16 v45, v33, v9
    v_dot2c_f32_bf16 v44, v30, v10
    v_dot2c_f32_bf16 v45, v34, v10
    v_dot2c_f32_bf16 v44, v31, v11
    v_dot2c_f32_bf16 v45, v35, v11
    s_waitcnt vmcnt(9)
    s_bitcmp1_b32 s54, 23
    s_cbranch_scc1 L_w110
    s_waitcnt vmcnt(7)
    s_bitcmp1_b32 s53, 23
    s_cbranch_scc1 L_w110
    s_waitcnt vmcnt(6)
    s_bitcmp1_b32 s52, 23
    s_cbranch_scc1 L_w110
    s_waitcnt vmcnt(4)
L_w110:
    s_xor_b32 s6, s97, 126976
    buffer_load_dwordx4 a[220:223], v2, s[36:39], s6 offen nt
    v_accvgpr_read_b32 v28, a72
    v_accvgpr_read_b32 v29, a73
    v_accvgpr_read_b32 v30, a74
    v_accvgpr_read_b32 v31, a75
    v_mov_b32 v46, 0
    v_accvgpr_read_b32 v32, a76
    v_accvgpr_read_b32 v33, a77
    v_accvgpr_read_b32 v34, a78
    v_accvgpr_read_b32 v35, a79
    v_mov_b32 v47, 0
    v_dot2c_f32_bf16 v46, v28, v8
    v_dot2c_f32_bf16 v47, v32, v8
    v_dot2c_f32_bf16 v46, v29, v9
    v_dot2c_f32_bf16 v47, v33, v9
    v_dot2c_f32_bf16 v46, v30, v10
    v_dot2c_f32_bf16 v47, v34, v10
    v_dot2c_f32_bf16 v46, v31, v11
    v_dot2c_f32_bf16 v47, v35, v11
    s_waitcnt vmcnt(8)
    s_bitcmp1_b32 s54, 24
    s_cbranch_scc1 L_w111
    s_waitcnt vmcnt(7)
    s_bitcmp1_b32 s53, 24
    s_cbranch_scc1 L_w111
    s_waitcnt vmcnt(5)
    s_bitcmp1_b32 s52, 24
    s_cbranch_scc1 L_w111
    s_waitcnt vmcnt(4)
L_w111:
    s_xor_b32 s6, s97, 131072
    buffer_load_dwordx4 a[224:227], v2, s[36:39], s6 offen nt
    v_accvgpr_read_b32 v28, a80
    v_accvgpr_read_b32 v29, a81
    v_accvgpr_read_b32 v30, a82
    v_accvgpr_read_b32 v31, a83
    v_mov_b32 v48, 0
    v_accvgpr_read_b32 v32, a84
    v_accvgpr_read_b32 v33, a85
    v_accvgpr_read_b32 v34, a86
    v_accvgpr_read_b32 v35, a87
    v_mov_b32 v49, 0
    v_dot2c_f32_bf16 v48, v28, v8
    v_dot2c_f32_bf16 v49, v32, v8
    v_dot2c_f32_bf16 v48, v29, v9
    v_dot2c_f32_bf16 v49, v33, v9
    v_dot2c_f32_bf16 v48, v30, v10
    v_dot2c_f32_bf16 v49, v34, v10
    v_dot2c_f32_bf16 v48, v31, v11
    v_dot2c_f32_bf16 v49, v35, v11
    s_lshr_b32 s8, s13, 2
    s_sub_i32 s8, 136, s8
    v_mov_b32 v73, s8
    s_mov_b64 exec, 1
    global_store_byte v72, v73, s[30:31] offset:256
    s_mov_b64 exec, -1
    s_waitcnt vmcnt(9)
    s_bitcmp1_b32 s54, 24
    s_cbranch_scc1 L_w112
    s_waitcnt vmcnt(7)
    s_bitcmp1_b32 s53, 24
    s_cbranch_scc1 L_w112
    s_waitcnt vmcnt(6)
    s_bitcmp1_b32 s52, 24
    s_cbranch_scc1 L_w112
    s_waitcnt vmcnt(4)
L_w112:
    s_xor_b32 s6, s97, 135168
    buffer_load_dwordx4 a[228:231], v2, s[36:39], s6 offen nt
    v_accvgpr_read_b32 v28, a88
    v_accvgpr_read_b32 v29, a89
    v_accvgpr_read_b32 v30, a90
    v_accvgpr_read_b32 v31, a91
    v_mov_b32 v50, 0
    v_accvgpr_read_b32 v32, a92
    v_accvgpr_read_b32 v33, a93
    v_accvgpr_read_b32 v34, a94
    v_accvgpr_read_b32 v35, a95
    v_mov_b32 v51, 0
    v_dot2c_f32_bf16 v50, v28, v8
    v_dot2c_f32_bf16 v51, v32, v8
    v_dot2c_f32_bf16 v50, v29, v9
    v_dot2c_f32_bf16 v51, v33, v9
    v_dot2c_f32_bf16 v50, v30, v10
    v_dot2c_f32_bf16 v51, v34, v10
    v_dot2c_f32_bf16 v50, v31, v11
    v_dot2c_f32_bf16 v51, v35, v11
    s_waitcnt vmcnt(8)
    s_bitcmp1_b32 s54, 24
    s_cbranch_scc1 L_w113
    s_waitcnt vmcnt(7)
    s_bitcmp1_b32 s53, 24
    s_cbranch_scc1 L_w113
    s_waitcnt vmcnt(5)
    s_bitcmp1_b32 s52, 24
    s_cbranch_scc1 L_w113
    s_waitcnt vmcnt(4)
L_w113:
    s_xor_b32 s6, s97, 139264
    buffer_load_dwordx4 a[232:235], v2, s[36:39], s6 offen nt
    v_add_f32_dpp v36, v36, v36 row_ror:8 row_mask:0xf bank_mask:0x3
    v_add_f32_dpp v37, v37, v37 row_ror:8 row_mask:0xf bank_mask:0x3
    v_add_f32_dpp v38, v38, v38 row_ror:8 row_mask:0xf bank_mask:0x3
    v_add_f32_dpp v39, v39, v39 row_ror:8 row_mask:0xf bank_mask:0x3
    v_add_f32_dpp v40, v40, v40 row_ror:8 row_mask:0xf bank_mask:0x3
    v_add_f32_dpp v41, v41, v41 row_ror:8 row_mask:0xf bank_mask:0x3
    v_add_f32_dpp v42, v42, v42 row_ror:8 row_mask:0xf bank_mask:0x3
    v_add_f32_dpp v43, v43, v43 row_ror:8 row_mask:0xf bank_mask:0x3
    v_add_f32_dpp v36, v44, v44 row_ror:8 row_mask:0xf bank_mask:0xc
    v_add_f32_dpp v37, v45, v45 row_ror:8 row_mask:0xf bank_mask:0xc
    v_add_f32_dpp v38, v46, v46 row_ror:8 row_mask:0xf bank_mask:0xc
    v_add_f32_dpp v39, v47, v47 row_ror:8 row_mask:0xf bank_mask:0xc
    v_add_f32_dpp v40, v48, v48 row_ror:8 row_mask:0xf bank_mask:0xc
    v_add_f32_dpp v41, v49, v49 row_ror:8 row_mask:0xf bank_mask:0xc
    v_add_f32_dpp v42, v50, v50 row_ror:8 row_mask:0xf bank_mask:0xc
    v_add_f32_dpp v43, v51, v51 row_ror:8 row_mask:0xf bank_mask:0xc
    v_add_f32_dpp v36, v36, v36 row_ror:12 row_mask:0xf bank_mask:0x5
    v_add_f32_dpp v37, v37, v37 row_ror:12 row_mask:0xf bank_mask:0x5
    v_add_f32_dpp v38, v38, v38 row_ror:12 row_mask:0xf bank_mask:0x5
    v_add_f32_dpp v39, v39, v39 row_ror:12 row_mask:0xf bank_mask:0x5
    v_add_f32_dpp v36, v40, v40 row_ror:4 row_mask:0xf bank_mask:0xa
    v_add_f32_dpp v37, v41, v41 row_ror:4 row_mask:0xf bank_mask:0xa
    v_add_f32_dpp v38, v42, v42 row_ror:4 row_mask:0xf bank_mask:0xa
    v_add_f32_dpp v39, v43, v43 row_ror:4 row_mask:0xf bank_mask:0xa
    v_add_f32_dpp v36, v36, v36 quad_perm:[1,0,3,2] row_mask:0xf bank_mask:0xf
    v_add_f32_dpp v37, v37, v37 quad_perm:[1,0,3,2] row_mask:0xf bank_mask:0xf
    v_add_f32_dpp v38, v38, v38 quad_perm:[1,0,3,2] row_mask:0xf bank_mask:0xf
    v_add_f32_dpp v39, v39, v39 quad_perm:[1,0,3,2] row_mask:0xf bank_mask:0xf
    v_add_f32_dpp v36, v36, v36 quad_perm:[2,3,0,1] row_mask:0xf bank_mask:0xf
    v_add_f32_dpp v37, v37, v37 quad_perm:[2,3,0,1] row_mask:0xf bank_mask:0xf
    v_add_f32_dpp v38, v38, v38 quad_perm:[2,3,0,1] row_mask:0xf bank_mask:0xf
    v_add_f32_dpp v39, v39, v39 quad_perm:[2,3,0,1] row_mask:0xf bank_mask:0xf
    v_cndmask_b32 v36, v36, v37, s[66:67]
    v_cndmask_b32 v38, v38, v39, s[66:67]
    v_cndmask_b32 v15, v36, v38, s[68:69]
    v_readlane_b32 s57, v76, 32
    v_sad_u8 v76, v76, 0, 0
    s_nop 1
    v_add_u32_dpp v76, v76, v76 row_ror:8 row_mask:0xf bank_mask:0xf
    s_nop 1
    v_add_u32_dpp v76, v76, v76 row_ror:4 row_mask:0xf bank_mask:0xf
    s_nop 1
    v_add_u32_dpp v76, v76, v76 row_ror:2 row_mask:0xf bank_mask:0xf
    s_nop 1
    v_add_u32_dpp v76, v76, v76 row_ror:1 row_mask:0xf bank_mask:0xf
    s_nop 0
    v_readlane_b32 s8, v76, 0
    v_readlane_b32 s9, v76, 16
    s_add_u32 s8, s8, s9
    s_sub_i32 s8, s56, s8
    s_sub_i32 s8, s8, s57
    s_cmp_lg_u32 s98, 0
    s_cselect_b32 s8, 0, s8
    s_mul_i32 s8, s8, 19
    s_ashr_i32 s8, s8, 10
    s_sub_i32 s13, s1, s8
    s_max_i32 s13, s13, 5
    s_min_i32 s13, s13, 24
    s_and_b32 s58, s13, 7
    s_lshl_b32 s58, s58, 3
    s_lshr_b64 s[58:59], vcc, s58
    s_and_b32 s58, s58, 0xff
    s_mul_i32 s58, s58, 0x01010101
    s_mov_b32 s59, s58
    s_lshr_b64 s[58:59], s[58:59], s0
    s_cmp_ge_u32 s13, 8
    s_cselect_b32 s52, -1, s58
    s_cselect_b32 s53, s58, 0
    s_cmp_ge_u32 s13, 16
    s_cselect_b32 s53, -1, s53
    s_cselect_b32 s54, s58, 0
    s_cmp_ge_u32 s13, 24
    s_cselect_b32 s54, -1, s54
    global_load_dword v74, v89, s[30:31] offset:256 nt
    s_lshr_b32 s8, s13, 2
    s_mul_i32 s8, s8, 80
    s_mul_i32 s9, s12, 98
    s_lshr_b32 s9, s9, 4
    s_add_u32 s8, s8, s9
    s_sub_i32 s10, 10920, s8
    s_waitcnt vmcnt(9)
    s_bitcmp1_b32 s54, 24
    s_cbranch_scc1 L_w114
    s_waitcnt vmcnt(7)
    s_bitcmp1_b32 s53, 24
    s_cbranch_scc1 L_w114
    s_waitcnt vmcnt(6)
    s_bitcmp1_b32 s52, 24
    s_cbranch_scc1 L_w114
    s_waitcnt vmcnt(5)
L_w114:
    s_xor_b32 s6, s97, 143360
    buffer_load_dwordx4 a[236:239], v2, s[36:39], s6 offen nt
    v_cvt_pk_bf16_f32 v52, v12, v13
    v_cvt_pk_bf16_f32 v53, v14, v15
    v_lshlrev_b32 v12, 16, v52
    v_and_b32 v13, 0xffff0000, v52
    v_lshlrev_b32 v14, 16, v53
    v_and_b32 v15, 0xffff0000, v53
    v_mul_f32 v12, 0x3db504f3, v12
    v_mul_f32 v13, 0x3db504f3, v13
    v_mul_f32 v14, 0x3db504f3, v14
    v_mul_f32 v15, 0x3db504f3, v15
    v_cvt_pk_bf16_f32 v52, v12, v13
    v_cvt_pk_bf16_f32 v53, v14, v15
    v_lshlrev_b32 v12, 16, v52
    v_and_b32 v13, 0xffff0000, v52
    v_lshlrev_b32 v14, 16, v53
    v_and_b32 v15, 0xffff0000, v53
    v_max_f32 v52, v12, v13
    v_max3_f32 v52, v52, v14, v15
    s_nop 1
    v_max_f32_dpp v52, v52, v52 row_ror:8 row_mask:0xf bank_mask:0xf
    s_nop 1
    v_max_f32_dpp v52, v52, v52 row_ror:4 row_mask:0xf bank_mask:0xf
    s_nop 1
    v_max_f32_dpp v52, v52, v52 row_ror:2 row_mask:0xf bank_mask:0xf
    s_nop 1
    v_max_f32_dpp v52, v52, v52 row_ror:1 row_mask:0xf bank_mask:0xf
    v_mov_b32 v53, v52
    s_nop 1
    v_permlane16_swap_b32 v52, v53
    v_max_f32 v52, v52, v53
    v_mov_b32 v53, v52
    s_nop 1
    v_permlane32_swap_b32 v52, v53
    v_max_f32 v52, v52, v53
    s_waitcnt vmcnt(8)
    s_bitcmp1_b32 s54, 25
    s_cbranch_scc1 L_w115
    s_waitcnt vmcnt(7)
    s_bitcmp1_b32 s53, 25
    s_cbranch_scc1 L_w115
    s_waitcnt vmcnt(6)
    s_bitcmp1_b32 s52, 25
    s_cbranch_scc1 L_w115
    s_waitcnt vmcnt(5)
L_w115:
    s_xor_b32 s6, s97, 147456
    buffer_load_dwordx4 a[240:243], v2, s[36:39], s6 offen nt
    v_sub_f32 v12, v12, v52
    v_sub_f32 v13, v13, v52
    v_sub_f32 v14, v14, v52
    v_sub_f32 v15, v15, v52
    v_mul_f32 v12, 0x3fb8aa3b, v12
    v_mul_f32 v13, 0x3fb8aa3b, v13
    v_mul_f32 v14, 0x3fb8aa3b, v14
    v_mul_f32 v15, 0x3fb8aa3b, v15
    v_exp_f32 v12, v12
    v_exp_f32 v13, v13
    v_exp_f32 v14, v14
    v_exp_f32 v15, v15
    v_add_f32 v53, v12, v13
    v_add_f32 v54, v14, v15
    v_add_f32 v53, v53, v54
    s_nop 1
    v_add_f32_dpp v53, v53, v53 row_ror:8 row_mask:0xf bank_mask:0xf
    s_nop 1
    v_add_f32_dpp v53, v53, v53 row_ror:4 row_mask:0xf bank_mask:0xf
    s_nop 1
    v_add_f32_dpp v53, v53, v53 row_ror:2 row_mask:0xf bank_mask:0xf
    s_nop 1
    v_add_f32_dpp v53, v53, v53 row_ror:1 row_mask:0xf bank_mask:0xf
    v_mov_b32 v54, v53
    s_nop 1
    v_permlane16_swap_b32 v53, v54
    v_add_f32 v53, v53, v54
    v_mov_b32 v54, v53
    s_nop 1
    v_permlane32_swap_b32 v53, v54
    v_add_f32 v53, v53, v54
    s_lshl_b32 s58, s3, 3
    v_mov_b32 v54, s58
    ds_write_b64 v54, v[52:53] offset:10752
    s_lshr_b32 s8, s13, 2
    s_sub_i32 s8, 144, s8
    v_mov_b32 v73, s8
    s_mov_b64 exec, 1
    global_store_byte v72, v73, s[30:31] offset:256
    s_mov_b64 exec, -1
    s_waitcnt vmcnt(9)
    s_bitcmp1_b32 s54, 25
    s_cbranch_scc1 L_w116
    s_waitcnt vmcnt(8)
    s_bitcmp1_b32 s53, 25
    s_cbranch_scc1 L_w116
    s_waitcnt vmcnt(7)
    s_bitcmp1_b32 s52, 25
    s_cbranch_scc1 L_w116
    s_waitcnt vmcnt(5)
L_w116:
    s_xor_b32 s6, s97, 151552
    buffer_load_dwordx4 a[244:247], v2, s[36:39], s6 offen nt
    s_waitcnt lgkmcnt(0)
    s_barrier
    v_mov_b32 v54, 0
    ds_read_b128 v[56:59], v54 offset:10752
    ds_read_b128 v[60:63], v54 offset:10768
    s_waitcnt vmcnt(9)
    s_bitcmp1_b32 s54, 25
    s_cbranch_scc1 L_w117
    s_waitcnt vmcnt(8)
    s_bitcmp1_b32 s53, 25
    s_cbranch_scc1 L_w117
    s_waitcnt vmcnt(6)
    s_bitcmp1_b32 s52, 25
    s_cbranch_scc1 L_w117
    s_waitcnt vmcnt(5)
L_w117:
    s_xor_b32 s6, s97, 155648
    buffer_load_dwordx4 a[248:251], v2, s[36:39], s6 offen nt
    s_waitcnt lgkmcnt(0)
    v_max_f32 v54, v56, v58
    v_max3_f32 v54, v54, v60, v62
    v_sub_f32 v56, v56, v54
    v_sub_f32 v58, v58, v54
    v_sub_f32 v60, v60, v54
    v_sub_f32 v62, v62, v54
    v_sub_f32 v52, v52, v54
    v_mul_f32 v56, 0x3fb8aa3b, v56
    v_mul_f32 v58, 0x3fb8aa3b, v58
    v_mul_f32 v60, 0x3fb8aa3b, v60
    v_mul_f32 v62, 0x3fb8aa3b, v62
    v_mul_f32 v52, 0x3fb8aa3b, v52
    v_exp_f32 v56, v56
    v_exp_f32 v58, v58
    v_exp_f32 v60, v60
    v_exp_f32 v62, v62
    v_exp_f32 v52, v52
    v_mul_f32 v54, v56, v57
    v_fmac_f32 v54, v58, v59
    v_fmac_f32 v54, v60, v61
    v_fmac_f32 v54, v62, v63
    v_rcp_f32 v54, v54
    s_nop 0
    v_mul_f32 v52, v52, v54
    v_mul_f32 v12, v12, v52
    v_mul_f32 v13, v13, v52
    v_mul_f32 v14, v14, v52
    v_mul_f32 v15, v15, v52
    v_cvt_pk_bf16_f32 v12, v12, v12
    v_cvt_pk_bf16_f32 v13, v13, v13
    v_cvt_pk_bf16_f32 v14, v14, v14
    v_cvt_pk_bf16_f32 v15, v15, v15
    v_and_b32_dpp v20, v12, v4 row_newbcast:0 row_mask:0xf bank_mask:0xf
    v_and_b32_dpp v21, v12, v5 row_newbcast:0 row_mask:0xf bank_mask:0xf
    v_and_b32_dpp v22, v12, v6 row_newbcast:0 row_mask:0xf bank_mask:0xf
    v_and_b32_dpp v23, v12, v7 row_newbcast:0 row_mask:0xf bank_mask:0xf
    s_waitcnt vmcnt(9)
    s_bitcmp1_b32 s54, 25
    s_cbranch_scc1 L_w118
    s_waitcnt vmcnt(7)
    s_bitcmp1_b32 s53, 25
    s_cbranch_scc1 L_w118
    s_waitcnt vmcnt(6)
    s_bitcmp1_b32 s52, 25
    s_cbranch_scc1 L_w118
    s_waitcnt vmcnt(4)
L_w118:
    s_xor_b32 s6, s97, 159744
    buffer_load_dwordx4 a[252:255], v2, s[36:39], s6 offen nt
    v_and_b32_dpp v24, v12, v4 row_newbcast:1 row_mask:0xf bank_mask:0xf
    v_and_b32_dpp v25, v12, v5 row_newbcast:1 row_mask:0xf bank_mask:0xf
    v_and_b32_dpp v26, v12, v6 row_newbcast:1 row_mask:0xf bank_mask:0xf
    v_and_b32_dpp v27, v12, v7 row_newbcast:1 row_mask:0xf bank_mask:0xf
    v_mfma_f32_16x16x32_bf16 v[16:19], v[20:23], a[96:99], 0
    v_and_b32_dpp v20, v12, v4 row_newbcast:2 row_mask:0xf bank_mask:0xf
    v_and_b32_dpp v21, v12, v5 row_newbcast:2 row_mask:0xf bank_mask:0xf
    v_and_b32_dpp v22, v12, v6 row_newbcast:2 row_mask:0xf bank_mask:0xf
    v_and_b32_dpp v23, v12, v7 row_newbcast:2 row_mask:0xf bank_mask:0xf
    v_mfma_f32_16x16x32_bf16 v[16:19], v[24:27], a[100:103], v[16:19]
    v_and_b32_dpp v24, v12, v4 row_newbcast:3 row_mask:0xf bank_mask:0xf
    v_and_b32_dpp v25, v12, v5 row_newbcast:3 row_mask:0xf bank_mask:0xf
    v_and_b32_dpp v26, v12, v6 row_newbcast:3 row_mask:0xf bank_mask:0xf
    v_and_b32_dpp v27, v12, v7 row_newbcast:3 row_mask:0xf bank_mask:0xf
    v_mfma_f32_16x16x32_bf16 v[16:19], v[20:23], a[104:107], v[16:19]
    s_waitcnt vmcnt(8)
    s_bitcmp1_b32 s54, 26
    s_cbranch_scc1 L_w119
    s_waitcnt vmcnt(7)
    s_bitcmp1_b32 s53, 26
    s_cbranch_scc1 L_w119
    s_waitcnt vmcnt(5)
    s_bitcmp1_b32 s52, 26
    s_cbranch_scc1 L_w119
    s_waitcnt vmcnt(4)
L_w119:
    s_xor_b32 s6, s97, 163840
    buffer_load_dwordx4 a[0:3], v2, s[36:39], s6 offen nt
    s_lshr_b32 s8, s13, 2
    s_sub_i32 s8, 152, s8
    v_mov_b32 v73, s8
    s_mov_b64 exec, 1
    global_store_byte v72, v73, s[30:31] offset:256
    s_mov_b64 exec, -1
    v_and_b32_dpp v20, v12, v4 row_newbcast:4 row_mask:0xf bank_mask:0xf
    v_and_b32_dpp v21, v12, v5 row_newbcast:4 row_mask:0xf bank_mask:0xf
    v_and_b32_dpp v22, v12, v6 row_newbcast:4 row_mask:0xf bank_mask:0xf
    v_and_b32_dpp v23, v12, v7 row_newbcast:4 row_mask:0xf bank_mask:0xf
    v_mfma_f32_16x16x32_bf16 v[16:19], v[24:27], a[108:111], v[16:19]
    v_and_b32_dpp v24, v12, v4 row_newbcast:5 row_mask:0xf bank_mask:0xf
    v_and_b32_dpp v25, v12, v5 row_newbcast:5 row_mask:0xf bank_mask:0xf
    v_and_b32_dpp v26, v12, v6 row_newbcast:5 row_mask:0xf bank_mask:0xf
    v_and_b32_dpp v27, v12, v7 row_newbcast:5 row_mask:0xf bank_mask:0xf
    v_mfma_f32_16x16x32_bf16 v[16:19], v[20:23], a[112:115], v[16:19]
    v_and_b32_dpp v20, v12, v4 row_newbcast:6 row_mask:0xf bank_mask:0xf
    v_and_b32_dpp v21, v12, v5 row_newbcast:6 row_mask:0xf bank_mask:0xf
    v_and_b32_dpp v22, v12, v6 row_newbcast:6 row_mask:0xf bank_mask:0xf
    v_and_b32_dpp v23, v12, v7 row_newbcast:6 row_mask:0xf bank_mask:0xf
    v_mfma_f32_16x16x32_bf16 v[16:19], v[24:27], a[116:119], v[16:19]
    s_waitcnt vmcnt(9)
    s_bitcmp1_b32 s54, 26
    s_cbranch_scc1 L_w120
    s_waitcnt vmcnt(7)
    s_bitcmp1_b32 s53, 26
    s_cbranch_scc1 L_w120
    s_waitcnt vmcnt(6)
    s_bitcmp1_b32 s52, 26
    s_cbranch_scc1 L_w120
    s_waitcnt vmcnt(4)
L_w120:
    s_xor_b32 s6, s97, 167936
    buffer_load_dwordx4 a[4:7], v2, s[36:39], s6 offen nt
    v_and_b32_dpp v24, v12, v4 row_newbcast:7 row_mask:0xf bank_mask:0xf
    v_and_b32_dpp v25, v12, v5 row_newbcast:7 row_mask:0xf bank_mask:0xf
    v_and_b32_dpp v26, v12, v6 row_newbcast:7 row_mask:0xf bank_mask:0xf
    v_and_b32_dpp v27, v12, v7 row_newbcast:7 row_mask:0xf bank_mask:0xf
    v_mfma_f32_16x16x32_bf16 v[16:19], v[20:23], a[120:123], v[16:19]
    v_and_b32_dpp v20, v12, v4 row_newbcast:8 row_mask:0xf bank_mask:0xf
    v_and_b32_dpp v21, v12, v5 row_newbcast:8 row_mask:0xf bank_mask:0xf
    v_and_b32_dpp v22, v12, v6 row_newbcast:8 row_mask:0xf bank_mask:0xf
    v_and_b32_dpp v23, v12, v7 row_newbcast:8 row_mask:0xf bank_mask:0xf
    v_mfma_f32_16x16x32_bf16 v[16:19], v[24:27], a[124:127], v[16:19]
    v_and_b32_dpp v24, v12, v4 row_newbcast:9 row_mask:0xf bank_mask:0xf
    v_and_b32_dpp v25, v12, v5 row_newbcast:9 row_mask:0xf bank_mask:0xf
    v_and_b32_dpp v26, v12, v6 row_newbcast:9 row_mask:0xf bank_mask:0xf
    v_and_b32_dpp v27, v12, v7 row_newbcast:9 row_mask:0xf bank_mask:0xf
    v_mfma_f32_16x16x32_bf16 v[16:19], v[20:23], a[128:131], v[16:19]
    s_waitcnt vmcnt(8)
    s_bitcmp1_b32 s54, 26
    s_cbranch_scc1 L_w121
    s_waitcnt vmcnt(7)
    s_bitcmp1_b32 s53, 26
    s_cbranch_scc1 L_w121
    s_waitcnt vmcnt(5)
    s_bitcmp1_b32 s52, 26
    s_cbranch_scc1 L_w121
    s_waitcnt vmcnt(4)
L_w121:
    s_xor_b32 s6, s97, 172032
    buffer_load_dwordx4 a[8:11], v2, s[36:39], s6 offen nt
    v_readlane_b32 s57, v74, 32
    v_sad_u8 v74, v74, 0, 0
    s_nop 1
    v_add_u32_dpp v74, v74, v74 row_ror:8 row_mask:0xf bank_mask:0xf
    s_nop 1
    v_add_u32_dpp v74, v74, v74 row_ror:4 row_mask:0xf bank_mask:0xf
    s_nop 1
    v_add_u32_dpp v74, v74, v74 row_ror:2 row_mask:0xf bank_mask:0xf
    s_nop 1
    v_add_u32_dpp v74, v74, v74 row_ror:1 row_mask:0xf bank_mask:0xf
    s_nop 0
    v_readlane_b32 s8, v74, 0
    v_readlane_b32 s9, v74, 16
    s_add_u32 s8, s8, s9
    s_sub_i32 s8, s10, s8
    s_sub_i32 s8, s8, s57
    s_cmp_lg_u32 s98, 0
    s_cselect_b32 s8, 0, s8
    s_mul_i32 s8, s8, 19
    s_ashr_i32 s8, s8, 10
    s_sub_i32 s13, s1, s8
    s_max_i32 s13, s13, 5
    s_min_i32 s13, s13, 24
    s_and_b32 s58, s13, 7
    s_lshl_b32 s58, s58, 3
    s_lshr_b64 s[58:59], vcc, s58
    s_and_b32 s58, s58, 0xff
    s_mul_i32 s58, s58, 0x01010101
    s_mov_b32 s59, s58
    s_lshr_b64 s[58:59], s[58:59], s0
    s_cmp_ge_u32 s13, 8
    s_cselect_b32 s52, -1, s58
    s_cselect_b32 s53, s58, 0
    s_cmp_ge_u32 s13, 16
    s_cselect_b32 s53, -1, s53
    s_cselect_b32 s54, s58, 0
    s_cmp_ge_u32 s13, 24
    s_cselect_b32 s54, -1, s54
    global_load_dword v75, v89, s[30:31] offset:256 nt
    s_lshr_b32 s8, s13, 2
    s_mul_i32 s8, s8, 80
    s_mul_i32 s9, s12, 106
    s_lshr_b32 s9, s9, 4
    s_add_u32 s8, s8, s9
    s_sub_i32 s11, 12200, s8
    v_and_b32_dpp v20, v12, v4 row_newbcast:10 row_mask:0xf bank_mask:0xf
    v_and_b32_dpp v21, v12, v5 row_newbcast:10 row_mask:0xf bank_mask:0xf
    v_and_b32_dpp v22, v12, v6 row_newbcast:10 row_mask:0xf bank_mask:0xf
    v_and_b32_dpp v23, v12, v7 row_newbcast:10 row_mask:0xf bank_mask:0xf
    v_mfma_f32_16x16x32_bf16 v[16:19], v[24:27], a[132:135], v[16:19]
    v_and_b32_dpp v24, v12, v4 row_newbcast:11 row_mask:0xf bank_mask:0xf
    v_and_b32_dpp v25, v12, v5 row_newbcast:11 row_mask:0xf bank_mask:0xf
    v_and_b32_dpp v26, v12, v6 row_newbcast:11 row_mask:0xf bank_mask:0xf
    v_and_b32_dpp v27, v12, v7 row_newbcast:11 row_mask:0xf bank_mask:0xf
    v_mfma_f32_16x16x32_bf16 v[16:19], v[20:23], a[136:139], v[16:19]
    v_and_b32_dpp v20, v12, v4 row_newbcast:12 row_mask:0xf bank_mask:0xf
    v_and_b32_dpp v21, v12, v5 row_newbcast:12 row_mask:0xf bank_mask:0xf
    v_and_b32_dpp v22, v12, v6 row_newbcast:12 row_mask:0xf bank_mask:0xf
    v_and_b32_dpp v23, v12, v7 row_newbcast:12 row_mask:0xf bank_mask:0xf
    v_mfma_f32_16x16x32_bf16 v[16:19], v[24:27], a[140:143], v[16:19]
    s_waitcnt vmcnt(9)
    s_bitcmp1_b32 s54, 26
    s_cbranch_scc1 L_w122
    s_waitcnt vmcnt(7)
    s_bitcmp1_b32 s53, 26
    s_cbranch_scc1 L_w122
    s_waitcnt vmcnt(6)
    s_bitcmp1_b32 s52, 26
    s_cbranch_scc1 L_w122
    s_waitcnt vmcnt(5)
L_w122:
    s_xor_b32 s6, s97, 176128
    buffer_load_dwordx4 a[12:15], v2, s[36:39], s6 offen nt
    v_and_b32_dpp v24, v12, v4 row_newbcast:13 row_mask:0xf bank_mask:0xf
    v_and_b32_dpp v25, v12, v5 row_newbcast:13 row_mask:0xf bank_mask:0xf
    v_and_b32_dpp v26, v12, v6 row_newbcast:13 row_mask:0xf bank_mask:0xf
    v_and_b32_dpp v27, v12, v7 row_newbcast:13 row_mask:0xf bank_mask:0xf
    v_mfma_f32_16x16x32_bf16 v[16:19], v[20:23], a[144:147], v[16:19]
    v_and_b32_dpp v20, v12, v4 row_newbcast:14 row_mask:0xf bank_mask:0xf
    v_and_b32_dpp v21, v12, v5 row_newbcast:14 row_mask:0xf bank_mask:0xf
    v_and_b32_dpp v22, v12, v6 row_newbcast:14 row_mask:0xf bank_mask:0xf
    v_and_b32_dpp v23, v12, v7 row_newbcast:14 row_mask:0xf bank_mask:0xf
    v_mfma_f32_16x16x32_bf16 v[16:19], v[24:27], a[148:151], v[16:19]
    v_and_b32_dpp v24, v12, v4 row_newbcast:15 row_mask:0xf bank_mask:0xf
    v_and_b32_dpp v25, v12, v5 row_newbcast:15 row_mask:0xf bank_mask:0xf
    v_and_b32_dpp v26, v12, v6 row_newbcast:15 row_mask:0xf bank_mask:0xf
    v_and_b32_dpp v27, v12, v7 row_newbcast:15 row_mask:0xf bank_mask:0xf
    v_mfma_f32_16x16x32_bf16 v[16:19], v[20:23], a[152:155], v[16:19]
    s_waitcnt vmcnt(8)
    s_bitcmp1_b32 s54, 27
    s_cbranch_scc1 L_w123
    s_waitcnt vmcnt(7)
    s_bitcmp1_b32 s53, 27
    s_cbranch_scc1 L_w123
    s_waitcnt vmcnt(6)
    s_bitcmp1_b32 s52, 27
    s_cbranch_scc1 L_w123
    s_waitcnt vmcnt(5)
L_w123:
    s_xor_b32 s6, s97, 180224
    buffer_load_dwordx4 a[16:19], v2, s[36:39], s6 offen nt
    s_lshr_b32 s8, s13, 2
    s_sub_i32 s8, 160, s8
    v_mov_b32 v73, s8
    s_mov_b64 exec, 1
    global_store_byte v72, v73, s[30:31] offset:256
    s_mov_b64 exec, -1
    v_and_b32_dpp v20, v13, v4 row_newbcast:0 row_mask:0xf bank_mask:0xf
    v_and_b32_dpp v21, v13, v5 row_newbcast:0 row_mask:0xf bank_mask:0xf
    v_and_b32_dpp v22, v13, v6 row_newbcast:0 row_mask:0xf bank_mask:0xf
    v_and_b32_dpp v23, v13, v7 row_newbcast:0 row_mask:0xf bank_mask:0xf
    v_mfma_f32_16x16x32_bf16 v[16:19], v[24:27], a[156:159], v[16:19]
    v_and_b32_dpp v24, v13, v4 row_newbcast:1 row_mask:0xf bank_mask:0xf
    v_and_b32_dpp v25, v13, v5 row_newbcast:1 row_mask:0xf bank_mask:0xf
    v_and_b32_dpp v26, v13, v6 row_newbcast:1 row_mask:0xf bank_mask:0xf
    v_and_b32_dpp v27, v13, v7 row_newbcast:1 row_mask:0xf bank_mask:0xf
    v_mfma_f32_16x16x32_bf16 v[16:19], v[20:23], a[160:163], v[16:19]
    v_and_b32_dpp v20, v13, v4 row_newbcast:2 row_mask:0xf bank_mask:0xf
    v_and_b32_dpp v21, v13, v5 row_newbcast:2 row_mask:0xf bank_mask:0xf
    v_and_b32_dpp v22, v13, v6 row_newbcast:2 row_mask:0xf bank_mask:0xf
    v_and_b32_dpp v23, v13, v7 row_newbcast:2 row_mask:0xf bank_mask:0xf
    v_mfma_f32_16x16x32_bf16 v[16:19], v[24:27], a[164:167], v[16:19]
    s_waitcnt vmcnt(9)
    s_bitcmp1_b32 s54, 27
    s_cbranch_scc1 L_w124
    s_waitcnt vmcnt(8)
    s_bitcmp1_b32 s53, 27
    s_cbranch_scc1 L_w124
    s_waitcnt vmcnt(7)
    s_bitcmp1_b32 s52, 27
    s_cbranch_scc1 L_w124
    s_waitcnt vmcnt(5)
L_w124:
    s_xor_b32 s6, s97, 184320
    buffer_load_dwordx4 a[20:23], v2, s[36:39], s6 offen nt
    v_and_b32_dpp v24, v13, v4 row_newbcast:3 row_mask:0xf bank_mask:0xf
    v_and_b32_dpp v25, v13, v5 row_newbcast:3 row_mask:0xf bank_mask:0xf
    v_and_b32_dpp v26, v13, v6 row_newbcast:3 row_mask:0xf bank_mask:0xf
    v_and_b32_dpp v27, v13, v7 row_newbcast:3 row_mask:0xf bank_mask:0xf
    v_mfma_f32_16x16x32_bf16 v[16:19], v[20:23], a[168:171], v[16:19]
    v_and_b32_dpp v20, v13, v4 row_newbcast:4 row_mask:0xf bank_mask:0xf
    v_and_b32_dpp v21, v13, v5 row_newbcast:4 row_mask:0xf bank_mask:0xf
    v_and_b32_dpp v22, v13, v6 row_newbcast:4 row_mask:0xf bank_mask:0xf
    v_and_b32_dpp v23, v13, v7 row_newbcast:4 row_mask:0xf bank_mask:0xf
    v_mfma_f32_16x16x32_bf16 v[16:19], v[24:27], a[172:175], v[16:19]
    v_and_b32_dpp v24, v13, v4 row_newbcast:5 row_mask:0xf bank_mask:0xf
    v_and_b32_dpp v25, v13, v5 row_newbcast:5 row_mask:0xf bank_mask:0xf
    v_and_b32_dpp v26, v13, v6 row_newbcast:5 row_mask:0xf bank_mask:0xf
    v_and_b32_dpp v27, v13, v7 row_newbcast:5 row_mask:0xf bank_mask:0xf
    v_mfma_f32_16x16x32_bf16 v[16:19], v[20:23], a[176:179], v[16:19]
    s_waitcnt vmcnt(9)
    s_bitcmp1_b32 s54, 27
    s_cbranch_scc1 L_w125
    s_waitcnt vmcnt(8)
    s_bitcmp1_b32 s53, 27
    s_cbranch_scc1 L_w125
    s_waitcnt vmcnt(6)
    s_bitcmp1_b32 s52, 27
    s_cbranch_scc1 L_w125
    s_waitcnt vmcnt(5)
L_w125:
    s_xor_b32 s6, s97, 188416
    buffer_load_dwordx4 a[24:27], v2, s[36:39], s6 offen nt
    v_and_b32_dpp v20, v13, v4 row_newbcast:6 row_mask:0xf bank_mask:0xf
    v_and_b32_dpp v21, v13, v5 row_newbcast:6 row_mask:0xf bank_mask:0xf
    v_and_b32_dpp v22, v13, v6 row_newbcast:6 row_mask:0xf bank_mask:0xf
    v_and_b32_dpp v23, v13, v7 row_newbcast:6 row_mask:0xf bank_mask:0xf
    v_mfma_f32_16x16x32_bf16 v[16:19], v[24:27], a[180:183], v[16:19]
    v_and_b32_dpp v24, v13, v4 row_newbcast:7 row_mask:0xf bank_mask:0xf
    v_and_b32_dpp v25, v13, v5 row_newbcast:7 row_mask:0xf bank_mask:0xf
    v_and_b32_dpp v26, v13, v6 row_newbcast:7 row_mask:0xf bank_mask:0xf
    v_and_b32_dpp v27, v13, v7 row_newbcast:7 row_mask:0xf bank_mask:0xf
    v_mfma_f32_16x16x32_bf16 v[16:19], v[20:23], a[184:187], v[16:19]
    v_and_b32_dpp v20, v13, v4 row_newbcast:8 row_mask:0xf bank_mask:0xf
    v_and_b32_dpp v21, v13, v5 row_newbcast:8 row_mask:0xf bank_mask:0xf
    v_and_b32_dpp v22, v13, v6 row_newbcast:8 row_mask:0xf bank_mask:0xf
    v_and_b32_dpp v23, v13, v7 row_newbcast:8 row_mask:0xf bank_mask:0xf
    v_mfma_f32_16x16x32_bf16 v[16:19], v[24:27], a[188:191], v[16:19]
    s_waitcnt vmcnt(9)
    s_bitcmp1_b32 s54, 27
    s_cbranch_scc1 L_w126
    s_waitcnt vmcnt(7)
    s_bitcmp1_b32 s53, 27
    s_cbranch_scc1 L_w126
    s_waitcnt vmcnt(6)
    s_bitcmp1_b32 s52, 27
    s_cbranch_scc1 L_w126
    s_waitcnt vmcnt(4)
L_w126:
    s_xor_b32 s6, s97, 192512
    buffer_load_dwordx4 a[28:31], v2, s[36:39], s6 offen nt
    v_and_b32_dpp v24, v13, v4 row_newbcast:9 row_mask:0xf bank_mask:0xf
    v_and_b32_dpp v25, v13, v5 row_newbcast:9 row_mask:0xf bank_mask:0xf
    v_and_b32_dpp v26, v13, v6 row_newbcast:9 row_mask:0xf bank_mask:0xf
    v_and_b32_dpp v27, v13, v7 row_newbcast:9 row_mask:0xf bank_mask:0xf
    v_mfma_f32_16x16x32_bf16 v[16:19], v[20:23], a[192:195], v[16:19]
    v_and_b32_dpp v20, v13, v4 row_newbcast:10 row_mask:0xf bank_mask:0xf
    v_and_b32_dpp v21, v13, v5 row_newbcast:10 row_mask:0xf bank_mask:0xf
    v_and_b32_dpp v22, v13, v6 row_newbcast:10 row_mask:0xf bank_mask:0xf
    v_and_b32_dpp v23, v13, v7 row_newbcast:10 row_mask:0xf bank_mask:0xf
    v_mfma_f32_16x16x32_bf16 v[16:19], v[24:27], a[196:199], v[16:19]
    v_and_b32_dpp v24, v13, v4 row_newbcast:11 row_mask:0xf bank_mask:0xf
    v_and_b32_dpp v25, v13, v5 row_newbcast:11 row_mask:0xf bank_mask:0xf
    v_and_b32_dpp v26, v13, v6 row_newbcast:11 row_mask:0xf bank_mask:0xf
    v_and_b32_dpp v27, v13, v7 row_newbcast:11 row_mask:0xf bank_mask:0xf
    v_mfma_f32_16x16x32_bf16 v[16:19], v[20:23], a[200:203], v[16:19]
    s_bitcmp1_b32 s54, 28
    s_cbranch_scc1 L_w127
    s_waitcnt vmcnt(8)
    s_bitcmp1_b32 s53, 28
    s_cbranch_scc1 L_w127
    s_waitcnt vmcnt(7)
    s_bitcmp1_b32 s52, 28
    s_cbranch_scc1 L_w127
    s_waitcnt vmcnt(5)
L_w127:
    s_xor_b32 s6, s97, 196608
    buffer_load_dwordx4 a[32:35], v2, s[36:39], s6 offen nt
    s_lshr_b32 s8, s13, 2
    s_sub_i32 s8, 168, s8
    v_mov_b32 v73, s8
    s_mov_b64 exec, 1
    global_store_byte v72, v73, s[30:31] offset:256
    s_mov_b64 exec, -1
    v_and_b32_dpp v20, v13, v4 row_newbcast:12 row_mask:0xf bank_mask:0xf
    v_and_b32_dpp v21, v13, v5 row_newbcast:12 row_mask:0xf bank_mask:0xf
    v_and_b32_dpp v22, v13, v6 row_newbcast:12 row_mask:0xf bank_mask:0xf
    v_and_b32_dpp v23, v13, v7 row_newbcast:12 row_mask:0xf bank_mask:0xf
    v_mfma_f32_16x16x32_bf16 v[16:19], v[24:27], a[204:207], v[16:19]
    v_and_b32_dpp v24, v13, v4 row_newbcast:13 row_mask:0xf bank_mask:0xf
    v_and_b32_dpp v25, v13, v5 row_newbcast:13 row_mask:0xf bank_mask:0xf
    v_and_b32_dpp v26, v13, v6 row_newbcast:13 row_mask:0xf bank_mask:0xf
    v_and_b32_dpp v27, v13, v7 row_newbcast:13 row_mask:0xf bank_mask:0xf
    v_mfma_f32_16x16x32_bf16 v[16:19], v[20:23], a[208:211], v[16:19]
    v_and_b32_dpp v20, v13, v4 row_newbcast:14 row_mask:0xf bank_mask:0xf
    v_and_b32_dpp v21, v13, v5 row_newbcast:14 row_mask:0xf bank_mask:0xf
    v_and_b32_dpp v22, v13, v6 row_newbcast:14 row_mask:0xf bank_mask:0xf
    v_and_b32_dpp v23, v13, v7 row_newbcast:14 row_mask:0xf bank_mask:0xf
    v_mfma_f32_16x16x32_bf16 v[16:19], v[24:27], a[212:215], v[16:19]
    s_waitcnt vmcnt(10)
    s_bitcmp1_b32 s54, 28
    s_cbranch_scc1 L_w128
    s_waitcnt vmcnt(9)
    s_bitcmp1_b32 s53, 28
    s_cbranch_scc1 L_w128
    s_waitcnt vmcnt(7)
    s_bitcmp1_b32 s52, 28
    s_cbranch_scc1 L_w128
    s_waitcnt vmcnt(6)
L_w128:
    s_xor_b32 s6, s97, 200704
    buffer_load_dwordx4 a[36:39], v2, s[36:39], s6 offen nt
    v_and_b32_dpp v24, v13, v4 row_newbcast:15 row_mask:0xf bank_mask:0xf
    v_and_b32_dpp v25, v13, v5 row_newbcast:15 row_mask:0xf bank_mask:0xf
    v_and_b32_dpp v26, v13, v6 row_newbcast:15 row_mask:0xf bank_mask:0xf
    v_and_b32_dpp v27, v13, v7 row_newbcast:15 row_mask:0xf bank_mask:0xf
    v_mfma_f32_16x16x32_bf16 v[16:19], v[20:23], a[216:219], v[16:19]
    v_and_b32_dpp v20, v14, v4 row_newbcast:0 row_mask:0xf bank_mask:0xf
    v_and_b32_dpp v21, v14, v5 row_newbcast:0 row_mask:0xf bank_mask:0xf
    v_and_b32_dpp v22, v14, v6 row_newbcast:0 row_mask:0xf bank_mask:0xf
    v_and_b32_dpp v23, v14, v7 row_newbcast:0 row_mask:0xf bank_mask:0xf
    v_mfma_f32_16x16x32_bf16 v[16:19], v[24:27], a[220:223], v[16:19]
    v_and_b32_dpp v24, v14, v4 row_newbcast:1 row_mask:0xf bank_mask:0xf
    v_and_b32_dpp v25, v14, v5 row_newbcast:1 row_mask:0xf bank_mask:0xf
    v_and_b32_dpp v26, v14, v6 row_newbcast:1 row_mask:0xf bank_mask:0xf
    v_and_b32_dpp v27, v14, v7 row_newbcast:1 row_mask:0xf bank_mask:0xf
    v_mfma_f32_16x16x32_bf16 v[16:19], v[20:23], a[224:227], v[16:19]
    s_waitcnt vmcnt(10)
    s_bitcmp1_b32 s54, 28
    s_cbranch_scc1 L_w129
    s_waitcnt vmcnt(8)
    s_bitcmp1_b32 s53, 28
    s_cbranch_scc1 L_w129
    s_waitcnt vmcnt(7)
    s_bitcmp1_b32 s52, 28
    s_cbranch_scc1 L_w129
    s_waitcnt vmcnt(5)
L_w129:
    s_xor_b32 s6, s97, 204800
    buffer_load_dwordx4 a[40:43], v2, s[36:39], s6 offen nt
    v_and_b32_dpp v20, v14, v4 row_newbcast:2 row_mask:0xf bank_mask:0xf
    v_and_b32_dpp v21, v14, v5 row_newbcast:2 row_mask:0xf bank_mask:0xf
    v_and_b32_dpp v22, v14, v6 row_newbcast:2 row_mask:0xf bank_mask:0xf
    v_and_b32_dpp v23, v14, v7 row_newbcast:2 row_mask:0xf bank_mask:0xf
    v_mfma_f32_16x16x32_bf16 v[16:19], v[24:27], a[228:231], v[16:19]
    v_and_b32_dpp v24, v14, v4 row_newbcast:3 row_mask:0xf bank_mask:0xf
    v_and_b32_dpp v25, v14, v5 row_newbcast:3 row_mask:0xf bank_mask:0xf
    v_and_b32_dpp v26, v14, v6 row_newbcast:3 row_mask:0xf bank_mask:0xf
    v_and_b32_dpp v27, v14, v7 row_newbcast:3 row_mask:0xf bank_mask:0xf
    v_mfma_f32_16x16x32_bf16 v[16:19], v[20:23], a[232:235], v[16:19]
    v_and_b32_dpp v20, v14, v4 row_newbcast:4 row_mask:0xf bank_mask:0xf
    v_and_b32_dpp v21, v14, v5 row_newbcast:4 row_mask:0xf bank_mask:0xf
    v_and_b32_dpp v22, v14, v6 row_newbcast:4 row_mask:0xf bank_mask:0xf
    v_and_b32_dpp v23, v14, v7 row_newbcast:4 row_mask:0xf bank_mask:0xf
    v_mfma_f32_16x16x32_bf16 v[16:19], v[24:27], a[236:239], v[16:19]
    s_waitcnt vmcnt(9)
    s_bitcmp1_b32 s54, 28
    s_cbranch_scc1 L_w130
    s_waitcnt vmcnt(8)
    s_bitcmp1_b32 s53, 28
    s_cbranch_scc1 L_w130
    s_waitcnt vmcnt(6)
    s_bitcmp1_b32 s52, 28
    s_cbranch_scc1 L_w130
    s_waitcnt vmcnt(5)
L_w130:
    s_xor_b32 s6, s97, 208896
    buffer_load_dwordx4 a[44:47], v2, s[36:39], s6 offen nt
    v_readlane_b32 s57, v75, 32
    v_sad_u8 v75, v75, 0, 0
    s_nop 1
    v_add_u32_dpp v75, v75, v75 row_ror:8 row_mask:0xf bank_mask:0xf
    s_nop 1
    v_add_u32_dpp v75, v75, v75 row_ror:4 row_mask:0xf bank_mask:0xf
    s_nop 1
    v_add_u32_dpp v75, v75, v75 row_ror:2 row_mask:0xf bank_mask:0xf
    s_nop 1
    v_add_u32_dpp v75, v75, v75 row_ror:1 row_mask:0xf bank_mask:0xf
    s_nop 0
    v_readlane_b32 s8, v75, 0
    v_readlane_b32 s9, v75, 16
    s_add_u32 s8, s8, s9
    s_sub_i32 s8, s11, s8
    s_sub_i32 s8, s8, s57
    s_cmp_lg_u32 s98, 0
    s_cselect_b32 s8, 0, s8
    s_mul_i32 s8, s8, 19
    s_ashr_i32 s8, s8, 10
    s_sub_i32 s13, s1, s8
    s_max_i32 s13, s13, 5
    s_min_i32 s13, s13, 24
    s_and_b32 s58, s13, 7
    s_lshl_b32 s58, s58, 3
    s_lshr_b64 s[58:59], vcc, s58
    s_and_b32 s58, s58, 0xff
    s_mul_i32 s58, s58, 0x01010101
    s_mov_b32 s59, s58
    s_lshr_b64 s[58:59], s[58:59], s0
    s_cmp_ge_u32 s13, 8
    s_cselect_b32 s52, -1, s58
    s_cselect_b32 s53, s58, 0
    s_cmp_ge_u32 s13, 16
    s_cselect_b32 s53, -1, s53
    s_cselect_b32 s54, s58, 0
    s_cmp_ge_u32 s13, 24
    s_cselect_b32 s54, -1, s54
    v_and_b32_dpp v24, v14, v4 row_newbcast:5 row_mask:0xf bank_mask:0xf
    v_and_b32_dpp v25, v14, v5 row_newbcast:5 row_mask:0xf bank_mask:0xf
    v_and_b32_dpp v26, v14, v6 row_newbcast:5 row_mask:0xf bank_mask:0xf
    v_and_b32_dpp v27, v14, v7 row_newbcast:5 row_mask:0xf bank_mask:0xf
    v_mfma_f32_16x16x32_bf16 v[16:19], v[20:23], a[240:243], v[16:19]
    v_and_b32_dpp v20, v14, v4 row_newbcast:6 row_mask:0xf bank_mask:0xf
    v_and_b32_dpp v21, v14, v5 row_newbcast:6 row_mask:0xf bank_mask:0xf
    v_and_b32_dpp v22, v14, v6 row_newbcast:6 row_mask:0xf bank_mask:0xf
    v_and_b32_dpp v23, v14, v7 row_newbcast:6 row_mask:0xf bank_mask:0xf
    v_mfma_f32_16x16x32_bf16 v[16:19], v[24:27], a[244:247], v[16:19]
    v_and_b32_dpp v24, v14, v4 row_newbcast:7 row_mask:0xf bank_mask:0xf
    v_and_b32_dpp v25, v14, v5 row_newbcast:7 row_mask:0xf bank_mask:0xf
    v_and_b32_dpp v26, v14, v6 row_newbcast:7 row_mask:0xf bank_mask:0xf
    v_and_b32_dpp v27, v14, v7 row_newbcast:7 row_mask:0xf bank_mask:0xf
    v_mfma_f32_16x16x32_bf16 v[16:19], v[20:23], a[248:251], v[16:19]
    s_waitcnt vmcnt(9)
    s_bitcmp1_b32 s54, 29
    s_cbranch_scc1 L_w131
    s_waitcnt vmcnt(7)
    s_bitcmp1_b32 s53, 29
    s_cbranch_scc1 L_w131
    s_waitcnt vmcnt(6)
    s_bitcmp1_b32 s52, 29
    s_cbranch_scc1 L_w131
    s_waitcnt vmcnt(5)
L_w131:
    s_xor_b32 s6, s97, 212992
    buffer_load_dwordx4 a[48:51], v2, s[36:39], s6 offen nt
    v_and_b32 v52, 15, v1
    v_lshrrev_b32 v53, 4, v1
    v_and_b32 v56, 1, v53
    v_lshlrev_b32 v54, 5, v52
    v_lshl_add_u32 v54, v56, 4, v54
    s_lshl_b32 s58, s3, 9
    v_add_u32 v54, s58, v54
    v_lshlrev_b32 v55, 3, v1
    v_add_u32 v55, 10816, v55
    v_bfe_u32 v57, v1, 3, 1
    s_lshl_b32 s58, s55, 12
    s_add_u32 s58, s58, s98
    s_add_u32 s58, s58, 524288
    v_lshl_add_u32 v36, v1, 4, s58
    v_add_u32 v43, s58, v2
    v_lshlrev_b32 v42, 4, v1
    v_mul_u32_u24 v37, 1088, v53
    v_bfe_u32 v58, v1, 2, 2
    v_lshl_add_u32 v37, v58, 7, v37
    v_and_b32 v58, 3, v1
    v_lshl_add_u32 v37, v58, 3, v37
    v_xor_b32 v57, s3, v57
    v_lshl_add_u32 v37, v57, 5, v37
    v_add_u32 v37, 36864, v37
    v_add_u32 v38, 43520, v37
    s_lshr_b32 s8, s13, 2
    s_sub_i32 s8, 176, s8
    v_mov_b32 v73, s8
    s_mov_b64 exec, 1
    global_store_byte v72, v73, s[30:31] offset:256
    s_mov_b64 exec, -1
    v_and_b32_dpp v20, v14, v4 row_newbcast:8 row_mask:0xf bank_mask:0xf
    v_and_b32_dpp v21, v14, v5 row_newbcast:8 row_mask:0xf bank_mask:0xf
    v_and_b32_dpp v22, v14, v6 row_newbcast:8 row_mask:0xf bank_mask:0xf
    v_and_b32_dpp v23, v14, v7 row_newbcast:8 row_mask:0xf bank_mask:0xf
    v_mfma_f32_16x16x32_bf16 v[16:19], v[24:27], a[252:255], v[16:19]
    v_and_b32_dpp v24, v14, v4 row_newbcast:9 row_mask:0xf bank_mask:0xf
    v_and_b32_dpp v25, v14, v5 row_newbcast:9 row_mask:0xf bank_mask:0xf
    v_and_b32_dpp v26, v14, v6 row_newbcast:9 row_mask:0xf bank_mask:0xf
    v_and_b32_dpp v27, v14, v7 row_newbcast:9 row_mask:0xf bank_mask:0xf
    v_mfma_f32_16x16x32_bf16 v[16:19], v[20:23], a[0:3], v[16:19]
    v_and_b32_dpp v20, v14, v4 row_newbcast:10 row_mask:0xf bank_mask:0xf
    v_and_b32_dpp v21, v14, v5 row_newbcast:10 row_mask:0xf bank_mask:0xf
    v_and_b32_dpp v22, v14, v6 row_newbcast:10 row_mask:0xf bank_mask:0xf
    v_and_b32_dpp v23, v14, v7 row_newbcast:10 row_mask:0xf bank_mask:0xf
    v_mfma_f32_16x16x32_bf16 v[16:19], v[24:27], a[4:7], v[16:19]
    s_waitcnt vmcnt(9)
    s_bitcmp1_b32 s54, 29
    s_cbranch_scc1 L_w132
    s_waitcnt vmcnt(8)
    s_bitcmp1_b32 s53, 29
    s_cbranch_scc1 L_w132
    s_waitcnt vmcnt(7)
    s_bitcmp1_b32 s52, 29
    s_cbranch_scc1 L_w132
    s_waitcnt vmcnt(6)
L_w132:
    s_xor_b32 s6, s97, 217088
    buffer_load_dwordx4 a[52:55], v2, s[36:39], s6 offen nt
    v_lshrrev_b32 v57, 5, v1
    s_lshl_b32 s58, s61, 6
    s_lshl_b32 s59, s3, 4
    s_add_u32 s58, s58, s59
    v_add_u32 v58, s58, v52
    s_lshl_b32 s58, s58, 5
    s_add_u32 s58, s58, 589824
    v_lshl_add_u32 v39, v52, 2, s58
    v_lshl_add_u32 v39, v57, 6, v39
    v_lshl_add_u32 v39, v56, 8, v39
    s_mul_i32 s58, s55, 10
    s_add_u32 s58, s58, s61
    s_and_b32 s58, s58, 15
    s_lshl_b32 s58, s58, 7
    s_add_u32 s58, s58, 610304
    v_mul_u32_u24 v40, 5632, v1
    v_add_u32 v40, s58, v40
    v_mov_b32 v41, 1
    v_mov_b32 v44, 0
    v_mov_b32 v45, 0
    v_mov_b32 v46, 0
    v_mov_b32 v47, 0
    s_or_b32 s58, s55, s60
    s_cbranch_scc1 L_ci133
    v_mul_u32_u24 v57, 1312, v56
    v_lshl_add_u32 v57, v58, 1, v57
    v_add_u32 v57, 123904, v57
    ds_read_u16_d16_hi v44, v57 offset:0
    ds_read_u16_d16_hi v45, v57 offset:2624
    ds_read_u16_d16_hi v46, v57 offset:5248
    ds_read_u16_d16_hi v47, v57 offset:7872
L_ci133:
    v_and_b32_dpp v24, v14, v4 row_newbcast:11 row_mask:0xf bank_mask:0xf
    v_and_b32_dpp v25, v14, v5 row_newbcast:11 row_mask:0xf bank_mask:0xf
    v_and_b32_dpp v26, v14, v6 row_newbcast:11 row_mask:0xf bank_mask:0xf
    v_and_b32_dpp v27, v14, v7 row_newbcast:11 row_mask:0xf bank_mask:0xf
    v_mfma_f32_16x16x32_bf16 v[16:19], v[20:23], a[8:11], v[16:19]
    v_and_b32_dpp v20, v14, v4 row_newbcast:12 row_mask:0xf bank_mask:0xf
    v_and_b32_dpp v21, v14, v5 row_newbcast:12 row_mask:0xf bank_mask:0xf
    v_and_b32_dpp v22, v14, v6 row_newbcast:12 row_mask:0xf bank_mask:0xf
    v_and_b32_dpp v23, v14, v7 row_newbcast:12 row_mask:0xf bank_mask:0xf
    v_mfma_f32_16x16x32_bf16 v[16:19], v[24:27], a[12:15], v[16:19]
    v_and_b32_dpp v24, v14, v4 row_newbcast:13 row_mask:0xf bank_mask:0xf
    v_and_b32_dpp v25, v14, v5 row_newbcast:13 row_mask:0xf bank_mask:0xf
    v_and_b32_dpp v26, v14, v6 row_newbcast:13 row_mask:0xf bank_mask:0xf
    v_and_b32_dpp v27, v14, v7 row_newbcast:13 row_mask:0xf bank_mask:0xf
    v_mfma_f32_16x16x32_bf16 v[16:19], v[20:23], a[16:19], v[16:19]
    s_waitcnt vmcnt(9)
    s_bitcmp1_b32 s54, 29
    s_cbranch_scc1 L_w134
    s_waitcnt vmcnt(8)
    s_bitcmp1_b32 s53, 29
    s_cbranch_scc1 L_w134
    s_waitcnt vmcnt(7)
    s_bitcmp1_b32 s52, 29
    s_cbranch_scc1 L_w134
    s_waitcnt vmcnt(5)
L_w134:
    s_xor_b32 s6, s97, 221184
    buffer_load_dwordx4 a[56:59], v2, s[36:39], s6 offen nt
    v_and_b32_dpp v20, v14, v4 row_newbcast:14 row_mask:0xf bank_mask:0xf
    v_and_b32_dpp v21, v14, v5 row_newbcast:14 row_mask:0xf bank_mask:0xf
    v_and_b32_dpp v22, v14, v6 row_newbcast:14 row_mask:0xf bank_mask:0xf
    v_and_b32_dpp v23, v14, v7 row_newbcast:14 row_mask:0xf bank_mask:0xf
    v_mfma_f32_16x16x32_bf16 v[16:19], v[24:27], a[20:23], v[16:19]
    v_and_b32_dpp v24, v14, v4 row_newbcast:15 row_mask:0xf bank_mask:0xf
    v_and_b32_dpp v25, v14, v5 row_newbcast:15 row_mask:0xf bank_mask:0xf
    v_and_b32_dpp v26, v14, v6 row_newbcast:15 row_mask:0xf bank_mask:0xf
    v_and_b32_dpp v27, v14, v7 row_newbcast:15 row_mask:0xf bank_mask:0xf
    v_mfma_f32_16x16x32_bf16 v[16:19], v[20:23], a[24:27], v[16:19]
    s_waitcnt vmcnt(9)
    s_bitcmp1_b32 s54, 29
    s_cbranch_scc1 L_w135
    s_waitcnt vmcnt(8)
    s_bitcmp1_b32 s53, 29
    s_cbranch_scc1 L_w135
    s_waitcnt vmcnt(6)
    s_bitcmp1_b32 s52, 29
    s_cbranch_scc1 L_w135
    s_waitcnt vmcnt(5)
L_w135:
    s_xor_b32 s6, s97, 225280
    buffer_load_dwordx4 a[60:63], v2, s[36:39], s6 offen nt
    v_and_b32_dpp v20, v15, v4 row_newbcast:0 row_mask:0xf bank_mask:0xf
    v_and_b32_dpp v21, v15, v5 row_newbcast:0 row_mask:0xf bank_mask:0xf
    v_and_b32_dpp v22, v15, v6 row_newbcast:0 row_mask:0xf bank_mask:0xf
    v_and_b32_dpp v23, v15, v7 row_newbcast:0 row_mask:0xf bank_mask:0xf
    v_mfma_f32_16x16x32_bf16 v[16:19], v[24:27], a[28:31], v[16:19]
    s_waitcnt vmcnt(9)
    s_bitcmp1_b32 s54, 30
    s_cbranch_scc1 L_w136
    s_waitcnt vmcnt(7)
    s_bitcmp1_b32 s53, 30
    s_cbranch_scc1 L_w136
    s_waitcnt vmcnt(6)
    s_bitcmp1_b32 s52, 30
    s_cbranch_scc1 L_w136
    s_waitcnt vmcnt(5)
L_w136:
    s_xor_b32 s6, s97, 229376
    buffer_load_dwordx4 a[64:67], v2, s[36:39], s6 offen nt
    s_lshr_b32 s8, s13, 2
    s_sub_i32 s8, 184, s8
    v_mov_b32 v73, s8
    s_mov_b64 exec, 1
    global_store_byte v72, v73, s[30:31] offset:256
    s_mov_b64 exec, -1
    v_and_b32_dpp v24, v15, v4 row_newbcast:1 row_mask:0xf bank_mask:0xf
    v_and_b32_dpp v25, v15, v5 row_newbcast:1 row_mask:0xf bank_mask:0xf
    v_and_b32_dpp v26, v15, v6 row_newbcast:1 row_mask:0xf bank_mask:0xf
    v_and_b32_dpp v27, v15, v7 row_newbcast:1 row_mask:0xf bank_mask:0xf
    v_mfma_f32_16x16x32_bf16 v[16:19], v[20:23], a[32:35], v[16:19]
    s_waitcnt vmcnt(9)
    s_bitcmp1_b32 s54, 30
    s_cbranch_scc1 L_w137
    s_waitcnt vmcnt(8)
    s_bitcmp1_b32 s53, 30
    s_cbranch_scc1 L_w137
    s_waitcnt vmcnt(7)
    s_bitcmp1_b32 s52, 30
    s_cbranch_scc1 L_w137
    s_waitcnt vmcnt(6)
L_w137:
    s_xor_b32 s6, s97, 233472
    buffer_load_dwordx4 a[68:71], v2, s[36:39], s6 offen nt
    v_and_b32_dpp v20, v15, v4 row_newbcast:2 row_mask:0xf bank_mask:0xf
    v_and_b32_dpp v21, v15, v5 row_newbcast:2 row_mask:0xf bank_mask:0xf
    v_and_b32_dpp v22, v15, v6 row_newbcast:2 row_mask:0xf bank_mask:0xf
    v_and_b32_dpp v23, v15, v7 row_newbcast:2 row_mask:0xf bank_mask:0xf
    v_mfma_f32_16x16x32_bf16 v[16:19], v[24:27], a[36:39], v[16:19]
    s_waitcnt vmcnt(9)
    s_bitcmp1_b32 s54, 30
    s_cbranch_scc1 L_w138
    s_waitcnt vmcnt(8)
    s_bitcmp1_b32 s53, 30
    s_cbranch_scc1 L_w138
    s_waitcnt vmcnt(7)
    s_bitcmp1_b32 s52, 30
    s_cbranch_scc1 L_w138
    s_waitcnt vmcnt(5)
L_w138:
    s_xor_b32 s6, s97, 237568
    buffer_load_dwordx4 a[72:75], v2, s[36:39], s6 offen nt
    v_and_b32_dpp v24, v15, v4 row_newbcast:3 row_mask:0xf bank_mask:0xf
    v_and_b32_dpp v25, v15, v5 row_newbcast:3 row_mask:0xf bank_mask:0xf
    v_and_b32_dpp v26, v15, v6 row_newbcast:3 row_mask:0xf bank_mask:0xf
    v_and_b32_dpp v27, v15, v7 row_newbcast:3 row_mask:0xf bank_mask:0xf
    v_mfma_f32_16x16x32_bf16 v[16:19], v[20:23], a[40:43], v[16:19]
    s_waitcnt vmcnt(9)
    s_bitcmp1_b32 s54, 30
    s_cbranch_scc1 L_w139
    s_waitcnt vmcnt(8)
    s_bitcmp1_b32 s53, 30
    s_cbranch_scc1 L_w139
    s_waitcnt vmcnt(6)
    s_bitcmp1_b32 s52, 30
    s_cbranch_scc1 L_w139
    s_waitcnt vmcnt(5)
L_w139:
    s_xor_b32 s6, s97, 241664
    buffer_load_dwordx4 a[76:79], v2, s[36:39], s6 offen nt
    v_and_b32_dpp v20, v15, v4 row_newbcast:4 row_mask:0xf bank_mask:0xf
    v_and_b32_dpp v21, v15, v5 row_newbcast:4 row_mask:0xf bank_mask:0xf
    v_and_b32_dpp v22, v15, v6 row_newbcast:4 row_mask:0xf bank_mask:0xf
    v_and_b32_dpp v23, v15, v7 row_newbcast:4 row_mask:0xf bank_mask:0xf
    v_mfma_f32_16x16x32_bf16 v[16:19], v[24:27], a[44:47], v[16:19]
    s_waitcnt vmcnt(9)
    s_bitcmp1_b32 s54, 31
    s_cbranch_scc1 L_w140
    s_waitcnt vmcnt(7)
    s_bitcmp1_b32 s53, 31
    s_cbranch_scc1 L_w140
    s_waitcnt vmcnt(6)
    s_bitcmp1_b32 s52, 31
    s_cbranch_scc1 L_w140
    s_waitcnt vmcnt(5)
L_w140:
    s_xor_b32 s6, s97, 245760
    buffer_load_dwordx4 a[80:83], v2, s[36:39], s6 offen nt
    v_and_b32_dpp v24, v15, v4 row_newbcast:5 row_mask:0xf bank_mask:0xf
    v_and_b32_dpp v25, v15, v5 row_newbcast:5 row_mask:0xf bank_mask:0xf
    v_and_b32_dpp v26, v15, v6 row_newbcast:5 row_mask:0xf bank_mask:0xf
    v_and_b32_dpp v27, v15, v7 row_newbcast:5 row_mask:0xf bank_mask:0xf
    v_mfma_f32_16x16x32_bf16 v[16:19], v[20:23], a[48:51], v[16:19]
    s_waitcnt vmcnt(8)
    s_bitcmp1_b32 s54, 31
    s_cbranch_scc1 L_w141
    s_waitcnt vmcnt(7)
    s_bitcmp1_b32 s53, 31
    s_cbranch_scc1 L_w141
    s_waitcnt vmcnt(6)
    s_bitcmp1_b32 s52, 31
    s_cbranch_scc1 L_w141
    s_waitcnt vmcnt(5)
L_w141:
    s_xor_b32 s6, s97, 249856
    buffer_load_dwordx4 a[84:87], v2, s[36:39], s6 offen nt
    v_and_b32_dpp v20, v15, v4 row_newbcast:6 row_mask:0xf bank_mask:0xf
    v_and_b32_dpp v21, v15, v5 row_newbcast:6 row_mask:0xf bank_mask:0xf
    v_and_b32_dpp v22, v15, v6 row_newbcast:6 row_mask:0xf bank_mask:0xf
    v_and_b32_dpp v23, v15, v7 row_newbcast:6 row_mask:0xf bank_mask:0xf
    v_mfma_f32_16x16x32_bf16 v[16:19], v[24:27], a[52:55], v[16:19]
    s_waitcnt vmcnt(8)
    s_bitcmp1_b32 s54, 31
    s_cbranch_scc1 L_w142
    s_waitcnt vmcnt(7)
    s_bitcmp1_b32 s53, 31
    s_cbranch_scc1 L_w142
    s_waitcnt vmcnt(6)
    s_bitcmp1_b32 s52, 31
    s_cbranch_scc1 L_w142
    s_waitcnt vmcnt(4)
L_w142:
    s_xor_b32 s6, s97, 253952
    buffer_load_dwordx4 a[88:91], v2, s[36:39], s6 offen nt
    v_and_b32_dpp v24, v15, v4 row_newbcast:7 row_mask:0xf bank_mask:0xf
    v_and_b32_dpp v25, v15, v5 row_newbcast:7 row_mask:0xf bank_mask:0xf
    v_and_b32_dpp v26, v15, v6 row_newbcast:7 row_mask:0xf bank_mask:0xf
    v_and_b32_dpp v27, v15, v7 row_newbcast:7 row_mask:0xf bank_mask:0xf
    v_mfma_f32_16x16x32_bf16 v[16:19], v[20:23], a[56:59], v[16:19]
    s_waitcnt vmcnt(8)
    s_bitcmp1_b32 s54, 31
    s_cbranch_scc1 L_w143
    s_waitcnt vmcnt(7)
    s_bitcmp1_b32 s53, 31
    s_cbranch_scc1 L_w143
    s_waitcnt vmcnt(5)
    s_bitcmp1_b32 s52, 31
    s_cbranch_scc1 L_w143
    s_waitcnt vmcnt(4)
L_w143:
    s_xor_b32 s6, s97, 258048
    buffer_load_dwordx4 a[92:95], v2, s[36:39], s6 offen nt
    v_and_b32_dpp v20, v15, v4 row_newbcast:8 row_mask:0xf bank_mask:0xf
    v_and_b32_dpp v21, v15, v5 row_newbcast:8 row_mask:0xf bank_mask:0xf
    v_and_b32_dpp v22, v15, v6 row_newbcast:8 row_mask:0xf bank_mask:0xf
    v_and_b32_dpp v23, v15, v7 row_newbcast:8 row_mask:0xf bank_mask:0xf
    v_mfma_f32_16x16x32_bf16 v[16:19], v[24:27], a[60:63], v[16:19]
L_tail:
    s_cmp_ge_u32 s60, 1
    s_cselect_b32 s46, 0, s46
    s_waitcnt vmcnt(8)
    s_bitcmp1_b32 s54, 31
    s_cbranch_scc1 L_w144
    s_waitcnt vmcnt(6)
    s_bitcmp1_b32 s53, 31
    s_cbranch_scc1 L_w144
    s_waitcnt vmcnt(5)
    s_bitcmp1_b32 s52, 31
    s_cbranch_scc1 L_w144
    s_waitcnt vmcnt(4)
L_w144:
    s_mov_b32 m0, s51
    s_addk_i32 s51, 1088
    buffer_load_dwordx4 v3, s[44:47], s64 offen nt lds
    s_add_u32 s64, s64, s62
    s_xor_b32 s62, s62, s63
    s_xor_b64 s[44:45], s[44:45], s[48:49]
    v_and_b32_dpp v24, v15, v4 row_newbcast:9 row_mask:0xf bank_mask:0xf
    v_and_b32_dpp v25, v15, v5 row_newbcast:9 row_mask:0xf bank_mask:0xf
    v_and_b32_dpp v26, v15, v6 row_newbcast:9 row_mask:0xf bank_mask:0xf
    v_and_b32_dpp v27, v15, v7 row_newbcast:9 row_mask:0xf bank_mask:0xf
    v_mfma_f32_16x16x32_bf16 v[16:19], v[20:23], a[64:67], v[16:19]
    s_waitcnt vmcnt(7)
    s_bitcmp1_b32 s54, 31
    s_cbranch_scc1 L_w145
    s_waitcnt vmcnt(6)
    s_bitcmp1_b32 s53, 31
    s_cbranch_scc1 L_w145
    s_waitcnt vmcnt(5)
    s_bitcmp1_b32 s52, 31
    s_cbranch_scc1 L_w145
    s_waitcnt vmcnt(4)
L_w145:
    s_mov_b32 m0, s51
    s_addk_i32 s51, 1088
    buffer_load_dwordx4 v3, s[44:47], s64 offen nt lds
    s_add_u32 s64, s64, s62
    s_xor_b32 s62, s62, s63
    s_xor_b64 s[44:45], s[44:45], s[48:49]
    v_and_b32_dpp v20, v15, v4 row_newbcast:10 row_mask:0xf bank_mask:0xf
    v_and_b32_dpp v21, v15, v5 row_newbcast:10 row_mask:0xf bank_mask:0xf
    v_and_b32_dpp v22, v15, v6 row_newbcast:10 row_mask:0xf bank_mask:0xf
    v_and_b32_dpp v23, v15, v7 row_newbcast:10 row_mask:0xf bank_mask:0xf
    v_mfma_f32_16x16x32_bf16 v[16:19], v[24:27], a[68:71], v[16:19]
    s_waitcnt vmcnt(7)
    s_bitcmp1_b32 s54, 31
    s_cbranch_scc1 L_w146
    s_waitcnt vmcnt(6)
    s_bitcmp1_b32 s53, 31
    s_cbranch_scc1 L_w146
    s_waitcnt vmcnt(5)
    s_bitcmp1_b32 s52, 31
    s_cbranch_scc1 L_w146
    s_waitcnt vmcnt(4)
L_w146:
    s_mov_b32 m0, s51
    s_addk_i32 s51, 1088
    buffer_load_dwordx4 v3, s[44:47], s64 offen nt lds
    s_add_u32 s64, s64, s62
    s_xor_b32 s62, s62, s63
    s_xor_b64 s[44:45], s[44:45], s[48:49]
    v_and_b32_dpp v24, v15, v4 row_newbcast:11 row_mask:0xf bank_mask:0xf
    v_and_b32_dpp v25, v15, v5 row_newbcast:11 row_mask:0xf bank_mask:0xf
    v_and_b32_dpp v26, v15, v6 row_newbcast:11 row_mask:0xf bank_mask:0xf
    v_and_b32_dpp v27, v15, v7 row_newbcast:11 row_mask:0xf bank_mask:0xf
    v_mfma_f32_16x16x32_bf16 v[16:19], v[20:23], a[72:75], v[16:19]
    v_and_b32_dpp v20, v15, v4 row_newbcast:12 row_mask:0xf bank_mask:0xf
    v_and_b32_dpp v21, v15, v5 row_newbcast:12 row_mask:0xf bank_mask:0xf
    v_and_b32_dpp v22, v15, v6 row_newbcast:12 row_mask:0xf bank_mask:0xf
    v_and_b32_dpp v23, v15, v7 row_newbcast:12 row_mask:0xf bank_mask:0xf
    s_waitcnt vmcnt(7)
    v_mfma_f32_16x16x32_bf16 v[16:19], v[24:27], a[76:79], v[16:19]
    v_and_b32_dpp v24, v15, v4 row_newbcast:13 row_mask:0xf bank_mask:0xf
    v_and_b32_dpp v25, v15, v5 row_newbcast:13 row_mask:0xf bank_mask:0xf
    v_and_b32_dpp v26, v15, v6 row_newbcast:13 row_mask:0xf bank_mask:0xf
    v_and_b32_dpp v27, v15, v7 row_newbcast:13 row_mask:0xf bank_mask:0xf
    s_waitcnt vmcnt(6)
    v_mfma_f32_16x16x32_bf16 v[16:19], v[20:23], a[80:83], v[16:19]
    v_and_b32_dpp v20, v15, v4 row_newbcast:14 row_mask:0xf bank_mask:0xf
    v_and_b32_dpp v21, v15, v5 row_newbcast:14 row_mask:0xf bank_mask:0xf
    v_and_b32_dpp v22, v15, v6 row_newbcast:14 row_mask:0xf bank_mask:0xf
    v_and_b32_dpp v23, v15, v7 row_newbcast:14 row_mask:0xf bank_mask:0xf
    s_waitcnt vmcnt(5)
    v_mfma_f32_16x16x32_bf16 v[16:19], v[24:27], a[84:87], v[16:19]
    v_and_b32_dpp v24, v15, v4 row_newbcast:15 row_mask:0xf bank_mask:0xf
    v_and_b32_dpp v25, v15, v5 row_newbcast:15 row_mask:0xf bank_mask:0xf
    v_and_b32_dpp v26, v15, v6 row_newbcast:15 row_mask:0xf bank_mask:0xf
    v_and_b32_dpp v27, v15, v7 row_newbcast:15 row_mask:0xf bank_mask:0xf
    s_waitcnt vmcnt(4)
    v_mfma_f32_16x16x32_bf16 v[16:19], v[20:23], a[88:91], v[16:19]
    s_waitcnt vmcnt(3)
    v_mfma_f32_16x16x32_bf16 v[16:19], v[24:27], a[92:95], v[16:19]
    s_nop 7
    ds_write_b128 v54, v[16:19] offset:10816
    s_waitcnt lgkmcnt(0)
    s_barrier
    s_cmp_lg_u32 s3, 0
    s_cbranch_scc1 L_pubq148
    ds_read2st64_b64 v[56:59], v55 offset0:0 offset1:1
    ds_read2st64_b64 v[60:63], v55 offset0:2 offset1:3
    s_cmp_lg_u32 s98, 0
    s_waitcnt lgkmcnt(1)
    v_pk_add_f32 v[56:57], v[56:57], v[58:59]
    s_waitcnt lgkmcnt(0)
    v_pk_add_f32 v[60:61], v[60:61], v[62:63]
    v_pk_add_f32 v[56:57], v[56:57], v[60:61]
    v_cvt_pk_bf16_f32 v56, v56, v57
    v_min_u32 v56, -2, v56
    s_cbranch_scc1 L_pubs147
    global_store_dword v93, v56, s[30:31]
L_pubq148:
    s_barrier
    s_cmp_lg_u32 s60, 0
    s_cbranch_scc1 L_role
    s_cmp_lg_u32 s98, 0
    s_cbranch_scc1 L_ws151
    global_load_dwordx4 v[60:63], v43, s[30:31] nt
L_wt152:
    ds_read_b64_tr_b16 v[96:97], v37 offset:0
    ds_read_b64_tr_b16 v[98:99], v37 offset:512
    ds_read_b64_tr_b16 v[104:105], v37 offset:21760
    ds_read_b64_tr_b16 v[106:107], v37 offset:22272
    ds_read_b64_tr_b16 v[112:113], v38 offset:0
    ds_read_b64_tr_b16 v[114:115], v38 offset:512
    ds_read_b64_tr_b16 v[120:121], v38 offset:21760
    ds_read_b64_tr_b16 v[122:123], v38 offset:22272
    s_mov_b32 s66, 0
    s_mov_b32 s68, 0
    s_mov_b32 s69, -1
L_wp149:
    s_waitcnt vmcnt(0)
    ds_write_b128 v2, v[60:63] offset:0
    v_max3_u32 v56, v60, v61, v62
    v_max_u32 v56, v56, v63
    v_cmp_eq_u32 vcc, -1, v56
    s_cbranch_vccz L_wd150
    s_add_u32 s66, s66, 1
    s_waitcnt lgkmcnt(0)
    s_cmp_lg_u32 s98, 0
    s_cbranch_scc1 L_wu153
    global_load_dwordx4 v[60:63], v43, s[30:31] nt
L_wv154:
    s_cmp_le_u32 s66, 262144
    s_cbranch_scc1 L_wp149
L_wd150:
    s_waitcnt lgkmcnt(0)
    s_barrier
    ds_read_b128 v[64:67], v42 offset:0
    ds_read_b128 v[68:71], v42 offset:1024
    ds_read_b128 v[72:75], v42 offset:2048
    ds_read_b128 v[76:79], v42 offset:3072
    ds_read_b64_tr_b16 v[100:101], v37 offset:4352
    ds_read_b64_tr_b16 v[102:103], v37 offset:4864
    ds_read_b64_tr_b16 v[116:117], v38 offset:4352
    ds_read_b64_tr_b16 v[118:119], v38 offset:4864
    ds_read_b64_tr_b16 v[108:109], v37 offset:26112
    ds_read_b64_tr_b16 v[110:111], v37 offset:26624
    ds_read_b64_tr_b16 v[124:125], v38 offset:26112
    ds_read_b64_tr_b16 v[126:127], v38 offset:26624
    s_cmp_lg_u32 s3, 1
    s_cbranch_scc1 L_ea155
    s_mov_b64 exec, 62
    global_atomic_add v40, v41, s[30:31] offset:2048
    s_mov_b64 exec, -1
L_ea155:
    s_waitcnt lgkmcnt(11)
    v_mfma_f32_16x16x32_bf16 v[44:47], v[64:67], v[96:99], v[44:47]
    v_mfma_f32_16x16x32_bf16 v[48:51], v[64:67], v[112:115], 0
    s_waitcnt lgkmcnt(9)
    v_mfma_f32_16x16x32_bf16 v[44:47], v[72:75], v[104:107], v[44:47]
    v_mfma_f32_16x16x32_bf16 v[48:51], v[72:75], v[120:123], v[48:51]
    s_waitcnt lgkmcnt(4)
    v_mfma_f32_16x16x32_bf16 v[44:47], v[68:71], v[100:103], v[44:47]
    v_mfma_f32_16x16x32_bf16 v[48:51], v[68:71], v[116:119], v[48:51]
    s_waitcnt lgkmcnt(0)
    v_mfma_f32_16x16x32_bf16 v[44:47], v[76:79], v[108:111], v[44:47]
    v_mfma_f32_16x16x32_bf16 v[48:51], v[76:79], v[124:127], v[48:51]
    s_nop 7
    v_permlane32_swap_b32 v48, v46
    v_permlane32_swap_b32 v49, v47
    v_cndmask_b32 v44, v44, v50, s[68:69]
    v_cndmask_b32 v45, v45, v51, s[68:69]
    v_cndmask_b32 v46, v46, v48, s[68:69]
    v_cndmask_b32 v47, v47, v49, s[68:69]
    v_add_f32 v45, v45, v47
    v_add_f32 v48, v44, v46
    v_add_f32 v44, v44, v46
    s_nop 1
    v_mov_b32_dpp v44, v45 row_ror:8 row_mask:0xf bank_mask:0xc
    v_mov_b32_dpp v45, v48 row_ror:8 row_mask:0xf bank_mask:0x3
    s_nop 1
    v_permlane16_swap_b32 v44, v45
    v_mov_b32 v48, v44
    s_nop 0
    v_mov_b32_dpp v44, v45 row_ror:4 row_mask:0xf bank_mask:0xa
    v_mov_b32_dpp v45, v48 row_ror:12 row_mask:0xf bank_mask:0x5
    global_atomic_add_f32 v39, v44, s[30:31]
    global_atomic_add_f32 v39, v45, s[30:31] offset:128
    s_waitcnt vmcnt(0)
    s_barrier
    s_cmp_lg_u32 s3, 0
    s_cbranch_scc1 L_apf
    s_mov_b64 exec, 255
    global_atomic_add v40, v41, s[30:31]
    s_mov_b64 exec, -1
    s_branch L_out
L_apf:
    s_cmp_lt_u32 s3, 3
    s_cbranch_scc1 L_out
    s_bitcmp1_b32 s55, 0
    s_cbranch_scc1 L_out
    s_cmp_lg_u32 s61, 9
    s_cbranch_scc1 L_out
    s_bitcmp1_b32 62, s99
    s_cbranch_scc0 L_out
    s_mul_i32 s58, s99, 5632
    s_add_u32 s58, s58, 612352
    v_lshl_add_u32 v88, v1, 7, s58
    s_and_b32 s58, s55, 1
    s_lshl_b32 s58, s58, 1
    s_add_u32 s58, s58, s3
    s_mul_i32 s58, s58, 5120
    s_add_u32 s58, s58, 579584
    s_mov_b32 s58, 589824
    v_lshl_add_u32 v87, v1, 7, s58
    v_add_u32 v85, 8192, v87
    v_add_u32 v84, 8192, v85
    v_mov_b32 v86, v89
    s_mov_b32 s66, 0
    s_mov_b64 exec, 0xffff
L_ap156:
    global_load_dword v89, v88, s[30:31] sc1
    s_add_u32 s66, s66, 1
    s_cmp_gt_u32 s66, 262144
    s_cbranch_scc1 L_aq157
    s_waitcnt vmcnt(0)
    v_cmp_gt_u32 vcc, 10, v89
    s_cbranch_vccnz L_ap156
L_aq157:
    s_mov_b64 exec, 1
    global_store_dword v86, v41, s[30:31] offset:388
    s_mov_b32 exec_lo, -1
    s_mov_b32 exec_hi, -1
    global_load_dword v89, v87, s[30:31] sc1
    global_load_dword v89, v85, s[30:31] sc1
    s_mov_b32 exec_hi, 0
    global_load_dword v89, v84, s[30:31] sc1
    s_mov_b64 exec, -1
    s_branch L_out
L_role:
    s_cmp_eq_u32 s60, 3
    s_cbranch_scc1 L_out
    s_cmp_eq_u32 s60, 2
    s_cbranch_scc1 L_D
    s_mul_i32 s58, s99, 5632
    s_add_u32 s58, s58, 610304
    v_lshl_add_u32 v88, v1, 7, s58
    s_mov_b32 s46, 2211840
    s_mov_b32 s64, 0
    s_add_u32 s51, s65, 0
    s_mov_b32 s62, 0
    s_mov_b64 s[44:45], s[20:21]
    s_bitcmp1_b32 s61, 0
    s_cselect_b32 s64, 497664, 0
    s_bitcmp1_b32 s61, 0
    s_cselect_b32 s42, -221184, 0
    s_cselect_b32 s43, -1, 1
    s_lshl_b32 s43, s43, 10
    s_mov_b32 m0, s51
    s_addk_i32 s51, 1088
    buffer_load_dwordx4 v3, s[44:47], s64 offen  lds
    s_add_u32 s64, s64, s62
    s_xor_b32 s62, s62, s63
    s_xor_b64 s[44:45], s[44:45], s[48:49]
    s_mov_b32 m0, s51
    s_addk_i32 s51, 1088
    buffer_load_dwordx4 v3, s[44:47], s64 offen  lds
    s_add_u32 s64, s64, s62
    s_xor_b32 s62, s62, s63
    s_xor_b64 s[44:45], s[44:45], s[48:49]
    s_mov_b32 m0, s51
    s_addk_i32 s51, 1088
    buffer_load_dwordx4 v3, s[44:47], s64 offen  lds
    s_add_u32 s64, s64, s62
    s_xor_b32 s62, s62, s63
    s_xor_b64 s[44:45], s[44:45], s[48:49]
    s_mov_b32 m0, s51
    s_addk_i32 s51, 1088
    buffer_load_dwordx4 v3, s[44:47], s64 offen  lds
    s_add_u32 s64, s64, s62
    s_xor_b32 s62, s62, s63
    s_xor_b64 s[44:45], s[44:45], s[48:49]
    s_mov_b32 m0, s51
    s_addk_i32 s51, 1088
    buffer_load_dwordx4 v3, s[44:47], s64 offen  lds
    s_add_u32 s64, s64, s62
    s_xor_b32 s62, s62, s63
    s_xor_b64 s[44:45], s[44:45], s[48:49]
    s_mov_b32 m0, s51
    s_addk_i32 s51, 1088
    buffer_load_dwordx4 v3, s[44:47], s64 offen  lds
    s_add_u32 s64, s64, s62
    s_xor_b32 s62, s62, s63
    s_xor_b64 s[44:45], s[44:45], s[48:49]
    v_lshrrev_b32 v54, 5, v1
    s_and_b32 s58, s61, 1
    v_xor_b32 v54, s58, v54
    v_mul_u32_u24 v55, 2176, v54
    v_and_b32 v54, 1, v53
    v_bfe_u32 v56, v1, 2, 2
    v_lshl_add_u32 v56, v54, 3, v56
    v_lshl_add_u32 v55, v56, 6, v55
    v_and_b32 v56, 3, v1
    v_lshl_add_u32 v55, v56, 3, v55
    v_add_u32 v55, s65, v55
    v_xor_b32 v56, 1, v54
    v_lshl_add_u32 v56, v56, 5, v55
    v_lshl_add_u32 v55, v54, 5, v55
    s_mul_i32 s58, s3, 5120
    s_add_u32 s58, s58, 591872
    v_lshl_add_u32 v10, v1, 4, s58
    v_subrev_u32 v9, s43, v10
    v_subrev_u32 v8, s43, v9
    v_add_u32 v11, s43, v10
    v_add_u32 v12, s43, v11
    s_mul_i32 s58, s3, 5888
    s_add_u32 s58, s58, 13312
    v_lshl_add_u32 v57, v1, 4, s58
    v_lshrrev_b32 v82, 5, v1
    v_bfe_u32 v83, v1, 2, 3
    v_bfe_u32 v84, v1, 1, 1
    v_and_b32 v85, 1, v1
    s_lshl_b32 s58, s3, 8
    s_add_u32 s58, s58, 13312
    v_lshl_add_u32 v59, v82, 1, v84
    v_mul_u32_u24 v59, 1152, v59
    v_add_u32 v59, s58, v59
    v_lshl_add_u32 v59, v85, 3, v59
    v_lshl_add_u32 v58, v83, 4, v59
    v_add_u32 v59, 128, v59
    v_lshrrev_b32 v60, 2, v83
    v_lshlrev_b32 v60, 8, v60
    v_lshl_add_u32 v60, v83, 4, v60
    v_and_b32 v84, 3, v83
    v_lshl_add_u32 v60, v84, 2, v60
    v_add_u32 v60, 17920, v60
    v_lshlrev_b32 v61, 4, v83
    v_add_u32 v61, 18432, v61
    s_lshl_b32 s58, s61, 9
    s_lshl_b32 s59, s3, 7
    s_add_u32 s58, s58, s59
    s_add_u32 s58, s58, 655360
    v_lshl_add_u32 v90, v1, 2, s58
    v_mov_b32 v15, 0x3727c5ac
    v_mov_b32 v62, 0x3f803f80
    v_mov_b32 v63, 0x3f803f80
    v_mov_b32 v64, 0x3f803f80
    v_mov_b32 v65, 0x3f803f80
    v_mov_b32 v66, 0x3f803f80
    v_mov_b32 v67, 0x3f803f80
    v_mov_b32 v68, 0x3f803f80
    v_mov_b32 v69, 0x3f803f80
    v_mov_b32 v70, 0x3f803f80
    v_mov_b32 v71, 0x3f803f80
    v_mov_b32 v72, 0x3f803f80
    v_mov_b32 v73, 0x3f803f80
    v_mov_b32 v74, 0x3f803f80
    v_mov_b32 v75, 0x3f803f80
    v_mov_b32 v76, 0x3f803f80
    v_mov_b32 v77, 0x3f803f80
    v_mov_b32 v78, 0x3f803f80
    v_mov_b32 v79, 0x3f803f80
    v_mov_b32 v80, 0x3f803f80
    v_mov_b32 v81, 0x3f803f80
    s_lshr_b32 s58, s61, 3
    s_mul_i32 s58, s58, 5632
    s_and_b32 s59, s61, 7
    s_lshl_b32 s59, s59, 7
    s_add_u32 s58, s58, s59
    s_add_u32 s58, s58, 614400
    v_mov_b32 v13, s58
    s_mov_b32 m0, s51
    s_addk_i32 s51, 1088
    buffer_load_dwordx4 v3, s[44:47], s64 offen  lds
    s_add_u32 s64, s64, s62
    s_xor_b32 s62, s62, s63
    s_xor_b64 s[44:45], s[44:45], s[48:49]
    s_mov_b32 m0, s51
    s_addk_i32 s51, 1088
    buffer_load_dwordx4 v3, s[44:47], s64 offen  lds
    s_add_u32 s64, s64, s62
    s_xor_b32 s62, s62, s63
    s_xor_b64 s[44:45], s[44:45], s[48:49]
    s_mov_b32 m0, s51
    s_addk_i32 s51, 1088
    buffer_load_dwordx4 v3, s[44:47], s64 offen  lds
    s_add_u32 s64, s64, s62
    s_xor_b32 s62, s62, s63
    s_xor_b64 s[44:45], s[44:45], s[48:49]
    s_mov_b32 m0, s51
    s_addk_i32 s51, 1088
    buffer_load_dwordx4 v3, s[44:47], s64 offen  lds
    s_add_u32 s64, s64, s62
    s_xor_b32 s62, s62, s63
    s_xor_b64 s[44:45], s[44:45], s[48:49]
    s_mov_b32 m0, s51
    s_addk_i32 s51, 1088
    buffer_load_dwordx4 v3, s[44:47], s64 offen  lds
    s_add_u32 s64, s64, s62
    s_xor_b32 s62, s62, s63
    s_xor_b64 s[44:45], s[44:45], s[48:49]
    s_mov_b32 m0, s51
    s_addk_i32 s51, 1088
    buffer_load_dwordx4 v3, s[44:47], s64 offen  lds
    s_add_u32 s64, s64, s62
    s_xor_b32 s62, s62, s63
    s_xor_b64 s[44:45], s[44:45], s[48:49]
    s_waitcnt vmcnt(8)
    ds_read_b64_tr_b16 v[96:97], v55 offset:0
    ds_read_b64_tr_b16 v[98:99], v55 offset:256
    ds_read_b64_tr_b16 v[100:101], v56 offset:0
    ds_read_b64_tr_b16 v[102:103], v56 offset:256
    ds_read_b64_tr_b16 v[104:105], v55 offset:1088
    ds_read_b64_tr_b16 v[106:107], v55 offset:1344
    ds_read_b64_tr_b16 v[108:109], v56 offset:1088
    ds_read_b64_tr_b16 v[110:111], v56 offset:1344
    s_mov_b32 m0, s51
    s_addk_i32 s51, 1088
    buffer_load_dwordx4 v3, s[44:47], s64 offen  lds
    s_add_u32 s64, s64, s62
    s_xor_b32 s62, s62, s63
    s_xor_b64 s[44:45], s[44:45], s[48:49]
    s_mov_b32 m0, s51
    s_addk_i32 s51, 1088
    buffer_load_dwordx4 v3, s[44:47], s64 offen  lds
    s_add_u32 s64, s64, s62
    s_xor_b32 s62, s62, s63
    s_xor_b64 s[44:45], s[44:45], s[48:49]
    s_mov_b32 m0, s51
    s_addk_i32 s51, 1088
    buffer_load_dwordx4 v3, s[44:47], s64 offen  lds
    s_add_u32 s64, s64, s62
    s_xor_b32 s62, s62, s63
    s_xor_b64 s[44:45], s[44:45], s[48:49]
    s_mov_b32 m0, s51
    s_addk_i32 s51, 1088
    buffer_load_dwordx4 v3, s[44:47], s64 offen  lds
    s_add_u32 s64, s64, s62
    s_xor_b32 s62, s62, s63
    s_xor_b64 s[44:45], s[44:45], s[48:49]
    s_waitcnt vmcnt(8)
    ds_read_b64_tr_b16 v[112:113], v55 offset:4352
    ds_read_b64_tr_b16 v[114:115], v55 offset:4608
    ds_read_b64_tr_b16 v[116:117], v56 offset:4352
    ds_read_b64_tr_b16 v[118:119], v56 offset:4608
    ds_read_b64_tr_b16 v[120:121], v55 offset:5440
    ds_read_b64_tr_b16 v[122:123], v55 offset:5696
    ds_read_b64_tr_b16 v[124:125], v56 offset:5440
    ds_read_b64_tr_b16 v[126:127], v56 offset:5696
    s_mov_b32 m0, s51
    s_addk_i32 s51, 1088
    buffer_load_dwordx4 v3, s[44:47], s64 offen  lds
    s_add_u32 s64, s64, s62
    s_xor_b32 s62, s62, s63
    s_xor_b64 s[44:45], s[44:45], s[48:49]
    s_mov_b32 m0, s51
    s_addk_i32 s51, 1088
    buffer_load_dwordx4 v3, s[44:47], s64 offen  lds
    s_add_u32 s64, s64, s62
    s_xor_b32 s62, s62, s63
    s_xor_b64 s[44:45], s[44:45], s[48:49]
    s_mov_b32 m0, s51
    s_addk_i32 s51, 1088
    buffer_load_dwordx4 v3, s[44:47], s64 offen  lds
    s_add_u32 s64, s64, s62
    s_xor_b32 s62, s62, s63
    s_xor_b64 s[44:45], s[44:45], s[48:49]
    s_mov_b32 m0, s51
    s_addk_i32 s51, 1088
    buffer_load_dwordx4 v3, s[44:47], s64 offen  lds
    s_add_u32 s64, s64, s62
    s_xor_b32 s62, s62, s63
    s_xor_b64 s[44:45], s[44:45], s[48:49]
    s_cmp_lg_u32 s3, 0
    s_cbranch_scc1 L_ep158
    s_mov_b32 exec_hi, 0
    s_mov_b32 exec_lo, 65535
    v_mov_b32 v86, v89
    s_mov_b64 exec, 1
    global_load_dword v87, v86, s[30:31] offset:388 nt
    s_mov_b64 exec, -1
L_ep158:
    s_mov_b64 s[48:49], s[30:31]
    s_cmp_eq_u32 s3, 3
    s_cselect_b32 s50, 655360, 0
    s_mov_b32 s51, 0x20000
    v_cmp_eq_u32 vcc, 0, v1
    s_nop 1
    v_cndmask_b32 v14, -1, v13, vcc
    s_waitcnt vmcnt(8)
    ds_read_b64_tr_b16 v[128:129], v55 offset:8704
    ds_read_b64_tr_b16 v[130:131], v55 offset:8960
    ds_read_b64_tr_b16 v[132:133], v56 offset:8704
    ds_read_b64_tr_b16 v[134:135], v56 offset:8960
    ds_read_b64_tr_b16 v[136:137], v55 offset:9792
    ds_read_b64_tr_b16 v[138:139], v55 offset:10048
    ds_read_b64_tr_b16 v[140:141], v56 offset:9792
    ds_read_b64_tr_b16 v[142:143], v56 offset:10048
    v_mov_b32 v93, 1
    s_mov_b32 s66, 0
    s_cmp_lg_u32 s3, 0
    s_cbranch_scc1 L_sd160
    s_cmp_lg_u32 s98, 0
    s_cbranch_scc1 L_gu162
    s_mov_b64 exec, 1
L_gt161:
    s_waitcnt vmcnt(0)
    v_cmp_eq_u32 vcc, 0, v87
    s_cbranch_vccz L_gu162
    global_load_dword v87, v86, s[30:31] offset:388 nt
    s_add_u32 s66, s66, 1
    s_cmp_le_u32 s66, 262144
    s_cbranch_scc1 L_gt161
L_gu162:
    s_mov_b64 exec, 65535
    global_load_dword v89, v88, s[30:31] sc1
    s_mov_b32 exec_hi, 0
    s_mov_b32 exec_lo, 65535
L_sp159:
    s_waitcnt vmcnt(0)
    v_cmp_gt_u32 vcc, 10, v89
    s_cbranch_vccz L_sd160
    global_load_dword v89, v88, s[30:31] sc1
    s_add_u32 s66, s66, 1
    s_cmp_le_u32 s66, 262144
    s_cbranch_scc1 L_sp159
L_sd160:
    s_mov_b64 exec, -1
    s_barrier
    global_load_dwordx4 v[176:179], v8, s[30:31] sc1
    global_load_dwordx4 v[180:183], v9, s[30:31] sc1
    global_load_dwordx4 v[184:187], v10, s[30:31] sc1
    global_load_dwordx4 v[188:191], v11, s[30:31] sc1
    global_load_dwordx4 v[192:195], v12, s[30:31] sc1
    s_waitcnt vmcnt(9)
    ds_read_b64_tr_b16 v[144:145], v55 offset:13056
    ds_read_b64_tr_b16 v[146:147], v55 offset:13312
    ds_read_b64_tr_b16 v[148:149], v56 offset:13056
    ds_read_b64_tr_b16 v[150:151], v56 offset:13312
    ds_read_b64_tr_b16 v[152:153], v55 offset:14144
    ds_read_b64_tr_b16 v[154:155], v55 offset:14400
    ds_read_b64_tr_b16 v[156:157], v56 offset:14144
    ds_read_b64_tr_b16 v[158:159], v56 offset:14400
    s_waitcnt vmcnt(5)
    ds_read_b64_tr_b16 v[160:161], v55 offset:17408
    ds_read_b64_tr_b16 v[162:163], v55 offset:17664
    ds_read_b64_tr_b16 v[164:165], v56 offset:17408
    ds_read_b64_tr_b16 v[166:167], v56 offset:17664
    ds_read_b64_tr_b16 v[168:169], v55 offset:18496
    ds_read_b64_tr_b16 v[170:171], v55 offset:18752
    ds_read_b64_tr_b16 v[172:173], v56 offset:18496
    ds_read_b64_tr_b16 v[174:175], v56 offset:18752
    s_waitcnt vmcnt(4) lgkmcnt(0)
    v_cvt_pk_bf16_f32 v40, v176, v177
    v_cvt_pk_bf16_f32 v41, v178, v179
    s_nop 0
    v_mov_b32_dpp v62, v40 quad_perm:[0,1,2,3] row_mask:0xf bank_mask:0x3
    v_mov_b32_dpp v63, v41 quad_perm:[0,1,2,3] row_mask:0xf bank_mask:0x3
    v_mov_b32_dpp v64, v40 row_ror:8 row_mask:0xf bank_mask:0x3
    v_mov_b32_dpp v65, v41 row_ror:8 row_mask:0xf bank_mask:0x3
    s_nop 1
    v_mfma_f32_16x16x32_bf16 v[20:23], v[96:99], v[62:65], 0
    s_waitcnt vmcnt(3)
    v_cvt_pk_bf16_f32 v42, v180, v181
    v_cvt_pk_bf16_f32 v43, v182, v183
    v_mfma_f32_16x16x32_bf16 v[24:27], v[100:103], v[62:65], 0
    v_mfma_f32_16x16x32_bf16 v[28:31], v[104:107], v[62:65], 0
    v_mov_b32_dpp v66, v42 quad_perm:[0,1,2,3] row_mask:0xf bank_mask:0x3
    v_mov_b32_dpp v67, v43 quad_perm:[0,1,2,3] row_mask:0xf bank_mask:0x3
    v_mfma_f32_16x16x32_bf16 v[32:35], v[108:111], v[62:65], 0
    v_mov_b32_dpp v68, v42 row_ror:8 row_mask:0xf bank_mask:0x3
    v_mov_b32_dpp v69, v43 row_ror:8 row_mask:0xf bank_mask:0x3
    v_mfma_f32_16x16x32_bf16 v[36:39], v[62:65], v[62:65], 0
    s_nop 0
    v_mfma_f32_16x16x32_bf16 v[20:23], v[112:115], v[66:69], v[20:23]
    s_waitcnt vmcnt(2)
    v_cvt_pk_bf16_f32 v40, v184, v185
    v_cvt_pk_bf16_f32 v41, v186, v187
    v_mfma_f32_16x16x32_bf16 v[24:27], v[116:119], v[66:69], v[24:27]
    v_mfma_f32_16x16x32_bf16 v[28:31], v[120:123], v[66:69], v[28:31]
    v_mov_b32_dpp v70, v40 quad_perm:[0,1,2,3] row_mask:0xf bank_mask:0x3
    v_mov_b32_dpp v71, v41 quad_perm:[0,1,2,3] row_mask:0xf bank_mask:0x3
    v_mfma_f32_16x16x32_bf16 v[32:35], v[124:127], v[66:69], v[32:35]
    v_mov_b32_dpp v72, v40 row_ror:8 row_mask:0xf bank_mask:0x3
    v_mov_b32_dpp v73, v41 row_ror:8 row_mask:0xf bank_mask:0x3
    v_mfma_f32_16x16x32_bf16 v[36:39], v[66:69], v[66:69], v[36:39]
    s_nop 0
    v_mfma_f32_16x16x32_bf16 v[20:23], v[128:131], v[70:73], v[20:23]
    s_waitcnt vmcnt(1)
    v_cvt_pk_bf16_f32 v42, v188, v189
    v_cvt_pk_bf16_f32 v43, v190, v191
    v_mfma_f32_16x16x32_bf16 v[24:27], v[132:135], v[70:73], v[24:27]
    buffer_store_dword v93, v14, s[48:51], 0 offen sc1
    v_mfma_f32_16x16x32_bf16 v[28:31], v[136:139], v[70:73], v[28:31]
    v_mov_b32_dpp v74, v42 quad_perm:[0,1,2,3] row_mask:0xf bank_mask:0x3
    v_mov_b32_dpp v75, v43 quad_perm:[0,1,2,3] row_mask:0xf bank_mask:0x3
    v_mfma_f32_16x16x32_bf16 v[32:35], v[140:143], v[70:73], v[32:35]
    v_mov_b32_dpp v76, v42 row_ror:8 row_mask:0xf bank_mask:0x3
    v_mov_b32_dpp v77, v43 row_ror:8 row_mask:0xf bank_mask:0x3
    v_mfma_f32_16x16x32_bf16 v[36:39], v[70:73], v[70:73], v[36:39]
    s_nop 0
    v_mfma_f32_16x16x32_bf16 v[20:23], v[144:147], v[74:77], v[20:23]
    s_waitcnt vmcnt(1)
    v_cvt_pk_bf16_f32 v40, v192, v193
    v_cvt_pk_bf16_f32 v41, v194, v195
    v_mfma_f32_16x16x32_bf16 v[24:27], v[148:151], v[74:77], v[24:27]
    v_mfma_f32_16x16x32_bf16 v[28:31], v[152:155], v[74:77], v[28:31]
    v_mov_b32_dpp v78, v40 quad_perm:[0,1,2,3] row_mask:0xf bank_mask:0x3
    v_mov_b32_dpp v79, v41 quad_perm:[0,1,2,3] row_mask:0xf bank_mask:0x3
    v_mfma_f32_16x16x32_bf16 v[32:35], v[156:159], v[74:77], v[32:35]
    v_mov_b32_dpp v80, v40 row_ror:8 row_mask:0xf bank_mask:0x3
    v_mov_b32_dpp v81, v41 row_ror:8 row_mask:0xf bank_mask:0x3
    v_mfma_f32_16x16x32_bf16 v[36:39], v[74:77], v[74:77], v[36:39]
    s_nop 0
    v_mfma_f32_16x16x32_bf16 v[20:23], v[160:163], v[78:81], v[20:23]
    v_mfma_f32_16x16x32_bf16 v[24:27], v[164:167], v[78:81], v[24:27]
    v_mfma_f32_16x16x32_bf16 v[28:31], v[168:171], v[78:81], v[28:31]
    v_mfma_f32_16x16x32_bf16 v[32:35], v[172:175], v[78:81], v[32:35]
    v_mfma_f32_16x16x32_bf16 v[36:39], v[78:81], v[78:81], v[36:39]
    s_nop 3
    ds_write_b128 v57, v[20:23] offset:0
    ds_write_b128 v57, v[24:27] offset:1152
    ds_write_b128 v57, v[28:31] offset:2304
    ds_write_b128 v57, v[32:35] offset:3456
    ds_write_b128 v57, v[36:39] offset:4608
    s_waitcnt lgkmcnt(0)
    s_barrier
    ds_read2st64_b32 v[20:21], v61 offset0:0 offset1:23
    ds_read2st64_b32 v[22:23], v61 offset0:46 offset1:69
    ds_read2st64_b32 v[24:25], v60 offset0:0 offset1:23
    ds_read2st64_b32 v[26:27], v60 offset0:46 offset1:69
    ds_read_b64 v[232:233], v59
    ds_read_b64 v[234:235], v59 offset:5888
    ds_read_b64 v[236:237], v59 offset:11776
    ds_read_b64 v[238:239], v59 offset:17664
    ds_read_b64 v[240:241], v58
    ds_read_b64 v[242:243], v58 offset:5888
    ds_read_b64 v[244:245], v58 offset:11776
    ds_read_b64 v[246:247], v58 offset:17664
    s_waitcnt lgkmcnt(10)
    v_pk_add_f32 v[20:21], v[20:21], v[22:23]
    s_waitcnt lgkmcnt(8)
    v_pk_add_f32 v[24:25], v[24:25], v[26:27]
    v_add_f32 v20, v20, v21
    v_add_f32 v24, v24, v25
    v_mul_f32 v20, 0x3acccccd, v20
    v_fmamk_f32 v24, v24, 0x3acccccd, v15
    v_fma_f32 v24, -v20, v20, v24
    v_cvt_pk_bf16_f32 v20, v20, v20
    v_max_f32 v24, v24, v15
    v_rsq_f32 v24, v24
    v_lshlrev_b32 v20, 16, v20
    s_waitcnt lgkmcnt(4)
    v_pk_add_f32 v[232:233], v[232:233], v[234:235]
    v_pk_add_f32 v[236:237], v[236:237], v[238:239]
    s_waitcnt lgkmcnt(0)
    v_pk_add_f32 v[240:241], v[240:241], v[242:243]
    v_pk_add_f32 v[244:245], v[244:245], v[246:247]
    v_pk_add_f32 v[232:233], v[232:233], v[236:237]
    v_pk_add_f32 v[240:241], v[240:241], v[244:245]
    v_mul_f32 v26, 0xbfb8aa3b, v24
    v_fma_f32 v240, -v232, v20, v240
    v_fma_f32 v241, -v233, v20, v241
    v_mul_f32 v242, v240, v26
    v_mul_f32 v243, v241, v26
    v_exp_f32 v242, v242
    v_exp_f32 v243, v243
    v_permlane32_swap_b32 v240, v244
    v_permlane32_swap_b32 v241, v245
    v_add_f32 v242, 1.0, v242
    v_add_f32 v243, 1.0, v243
    v_rcp_f32 v242, v242
    v_rcp_f32 v243, v243
    v_mul_f32 v244, v244, v24
    v_mul_f32 v245, v245, v24
    v_mul_f32 v242, v242, v244
    v_mul_f32 v243, v243, v245
    s_mov_b32 exec_hi, 0
    v_cvt_pk_bf16_f32 v242, v242, v243
    v_min_u32 v242, -2, v242
    global_store_dword v90, v242, s[30:31] sc1
    s_mov_b32 exec_hi, -1
    s_branch L_out
L_D:
    s_mov_b32 s46, 2211840
    s_mov_b32 s64, 0
    s_add_u32 s51, s65, 0
    s_and_b32 s57, s61, 3
    s_lshl_b32 s57, s57, 1
    s_min_u32 s57, s57, 5
    s_lshl_b32 s32, s57, 10
    s_mul_i32 s64, s57, 81920
    s_add_u32 s57, s57, 1
    s_cmp_eq_u32 s57, 7
    s_cselect_b32 s57, 0, s57
    s_mov_b32 m0, s51
    s_addk_i32 s51, 1088
    buffer_load_dwordx4 v3, s[44:47], s64 offen  lds
    s_add_u32 s64, s64, s62
    s_xor_b32 s62, s62, s63
    s_xor_b64 s[44:45], s[44:45], s[48:49]
    s_mov_b32 m0, s51
    s_addk_i32 s51, 1088
    buffer_load_dwordx4 v3, s[44:47], s64 offen  lds
    s_add_u32 s64, s64, s62
    s_xor_b32 s62, s62, s63
    s_xor_b64 s[44:45], s[44:45], s[48:49]
    s_lshl_b32 s33, s57, 10
    s_mul_i32 s64, s57, 81920
    s_add_u32 s57, s57, 1
    s_cmp_eq_u32 s57, 7
    s_cselect_b32 s57, 0, s57
    s_mov_b32 m0, s51
    s_addk_i32 s51, 1088
    buffer_load_dwordx4 v3, s[44:47], s64 offen  lds
    s_add_u32 s64, s64, s62
    s_xor_b32 s62, s62, s63
    s_xor_b64 s[44:45], s[44:45], s[48:49]
    s_mov_b32 m0, s51
    s_addk_i32 s51, 1088
    buffer_load_dwordx4 v3, s[44:47], s64 offen  lds
    s_add_u32 s64, s64, s62
    s_xor_b32 s62, s62, s63
    s_xor_b64 s[44:45], s[44:45], s[48:49]
    v_lshl_add_u32 v55, v1, 3, s65
    s_add_u32 s52, s30, 655360
    s_addc_u32 s53, s31, 0
    s_mov_b32 s54, 27648
    s_mov_b32 s55, 0x20000
    v_bfe_u32 v54, v1, 3, 1
    v_and_b32 v56, 7, v1
    v_lshlrev_b32 v57, 9, v54
    v_lshl_add_u32 v57, v53, 7, v57
    v_lshl_add_u32 v57, v56, 4, v57
    s_mul_i32 s58, s3, 7168
    v_add_u32 v57, s58, v57
    v_add_u32 v58, 4096, v57
    v_lshlrev_b32 v59, 6, v52
    v_lshl_add_u32 v59, v53, 4, v59
    s_lshl_b32 s58, s3, 10
    v_add_u32 v59, s58, v59
    v_lshlrev_b32 v60, 3, v1
    v_lshrrev_b32 v62, 3, v1
    v_mul_u32_u24 v61, 1280, v62
    v_lshl_add_u32 v61, v56, 2, v61
    s_lshl_b32 s58, s61, 5
    v_add_u32 v61, s58, v61
    s_lshl_b32 s58, s61, 9
    s_add_u32 s58, s58, 589824
    v_lshl_add_u32 v40, v62, 4, s58
    v_bfe_u32 v62, v1, 1, 2
    v_lshl_add_u32 v40, v62, 7, v40
    v_and_b32 v62, 1, v1
    v_lshl_add_u32 v40, v62, 3, v40
    s_mov_b32 s68, 0xff00ff00
    s_mov_b32 s69, 0xff00ff00
    s_mul_i32 s58, s3, 14
    v_add_u32 v14, s58, v52
    v_min_u32 v14, 53, v14
    v_lshrrev_b32 v15, 3, v14
    v_mul_u32_u24 v13, 5632, v15
    v_and_b32 v14, 7, v14
    v_lshl_add_u32 v13, v14, 7, v13
    v_add_u32 v13, 614400, v13
    s_lshl_b32 s34, s57, 10
    s_mul_i32 s64, s57, 81920
    s_add_u32 s57, s57, 1
    s_cmp_eq_u32 s57, 7
    s_cselect_b32 s57, 0, s57
    s_mov_b32 m0, s51
    s_addk_i32 s51, 1088
    buffer_load_dwordx4 v3, s[44:47], s64 offen  lds
    s_add_u32 s64, s64, s62
    s_xor_b32 s62, s62, s63
    s_xor_b64 s[44:45], s[44:45], s[48:49]
    s_mov_b32 m0, s51
    s_addk_i32 s51, 1088
    buffer_load_dwordx4 v3, s[44:47], s64 offen  lds
    s_add_u32 s64, s64, s62
    s_xor_b32 s62, s62, s63
    s_xor_b64 s[44:45], s[44:45], s[48:49]
    s_lshl_b32 s35, s57, 10
    s_mul_i32 s64, s57, 81920
    s_add_u32 s57, s57, 1
    s_cmp_eq_u32 s57, 7
    s_cselect_b32 s57, 0, s57
    s_mov_b32 m0, s51
    s_addk_i32 s51, 1088
    buffer_load_dwordx4 v3, s[44:47], s64 offen  lds
    s_add_u32 s64, s64, s62
    s_xor_b32 s62, s62, s63
    s_xor_b64 s[44:45], s[44:45], s[48:49]
    s_waitcnt vmcnt(6)
    ds_read_b64_tr_b16 v[96:97], v55 offset:0
    ds_read_b64_tr_b16 v[98:99], v55 offset:512
    s_mov_b32 m0, s51
    s_addk_i32 s51, 1088
    buffer_load_dwordx4 v3, s[44:47], s64 offen  lds
    s_add_u32 s64, s64, s62
    s_xor_b32 s62, s62, s63
    s_xor_b64 s[44:45], s[44:45], s[48:49]
    s_waitcnt vmcnt(6)
    ds_read_b64_tr_b16 v[100:101], v55 offset:1088
    ds_read_b64_tr_b16 v[102:103], v55 offset:1600
    s_lshl_b32 s36, s57, 10
    s_mul_i32 s64, s57, 81920
    s_add_u32 s57, s57, 1
    s_cmp_eq_u32 s57, 7
    s_cselect_b32 s57, 0, s57
    s_mov_b32 m0, s51
    s_addk_i32 s51, 1088
    buffer_load_dwordx4 v3, s[44:47], s64 offen  lds
    s_add_u32 s64, s64, s62
    s_xor_b32 s62, s62, s63
    s_xor_b64 s[44:45], s[44:45], s[48:49]
    s_waitcnt vmcnt(6)
    ds_read_b64_tr_b16 v[104:105], v55 offset:2176
    ds_read_b64_tr_b16 v[106:107], v55 offset:2688
    s_mov_b32 m0, s51
    s_addk_i32 s51, 1088
    buffer_load_dwordx4 v3, s[44:47], s64 offen  lds
    s_add_u32 s64, s64, s62
    s_xor_b32 s62, s62, s63
    s_xor_b64 s[44:45], s[44:45], s[48:49]
    s_waitcnt vmcnt(6)
    ds_read_b64_tr_b16 v[108:109], v55 offset:3264
    ds_read_b64_tr_b16 v[110:111], v55 offset:3776
    s_lshl_b32 s37, s57, 10
    s_mul_i32 s64, s57, 81920
    s_add_u32 s57, s57, 1
    s_cmp_eq_u32 s57, 7
    s_cselect_b32 s57, 0, s57
    s_mov_b32 m0, s51
    s_addk_i32 s51, 1088
    buffer_load_dwordx4 v3, s[44:47], s64 offen  lds
    s_add_u32 s64, s64, s62
    s_xor_b32 s62, s62, s63
    s_xor_b64 s[44:45], s[44:45], s[48:49]
    s_waitcnt vmcnt(6)
    ds_read_b64_tr_b16 v[112:113], v55 offset:4352
    ds_read_b64_tr_b16 v[114:115], v55 offset:4864
    s_mov_b32 m0, s51
    s_addk_i32 s51, 1088
    buffer_load_dwordx4 v3, s[44:47], s64 offen  lds
    s_add_u32 s64, s64, s62
    s_xor_b32 s62, s62, s63
    s_xor_b64 s[44:45], s[44:45], s[48:49]
    s_waitcnt vmcnt(6)
    ds_read_b64_tr_b16 v[116:117], v55 offset:5440
    ds_read_b64_tr_b16 v[118:119], v55 offset:5952
    s_lshl_b32 s38, s57, 10
    s_mul_i32 s64, s57, 81920
    s_add_u32 s57, s57, 1
    s_cmp_eq_u32 s57, 7
    s_cselect_b32 s57, 0, s57
    s_mov_b32 m0, s51
    s_addk_i32 s51, 1088
    buffer_load_dwordx4 v3, s[44:47], s64 offen  lds
    s_add_u32 s64, s64, s62
    s_xor_b32 s62, s62, s63
    s_xor_b64 s[44:45], s[44:45], s[48:49]
    s_waitcnt vmcnt(6)
    ds_read_b64_tr_b16 v[120:121], v55 offset:6528
    ds_read_b64_tr_b16 v[122:123], v55 offset:7040
    s_mov_b32 m0, s51
    s_addk_i32 s51, 1088
    buffer_load_dwordx4 v3, s[44:47], s64 offen  lds
    s_add_u32 s64, s64, s62
    s_xor_b32 s62, s62, s63
    s_xor_b64 s[44:45], s[44:45], s[48:49]
    s_waitcnt vmcnt(6)
    ds_read_b64_tr_b16 v[124:125], v55 offset:7616
    ds_read_b64_tr_b16 v[126:127], v55 offset:8128
    s_waitcnt vmcnt(5)
    ds_read_b64_tr_b16 v[128:129], v55 offset:8704
    ds_read_b64_tr_b16 v[130:131], v55 offset:9216
    s_waitcnt vmcnt(4)
    ds_read_b64_tr_b16 v[132:133], v55 offset:9792
    ds_read_b64_tr_b16 v[134:135], v55 offset:10304
    s_waitcnt vmcnt(3)
    ds_read_b64_tr_b16 v[136:137], v55 offset:10880
    ds_read_b64_tr_b16 v[138:139], v55 offset:11392
    s_waitcnt vmcnt(2)
    ds_read_b64_tr_b16 v[140:141], v55 offset:11968
    ds_read_b64_tr_b16 v[142:143], v55 offset:12480
    s_waitcnt vmcnt(1)
    ds_read_b64_tr_b16 v[144:145], v55 offset:13056
    ds_read_b64_tr_b16 v[146:147], v55 offset:13568
    s_waitcnt vmcnt(0)
    ds_read_b64_tr_b16 v[148:149], v55 offset:14144
    ds_read_b64_tr_b16 v[150:151], v55 offset:14656
    s_mul_i32 s58, s99, 5632
    s_add_u32 s58, s58, 610304
    v_lshl_add_u32 v88, v1, 7, s58
    s_mov_b32 s66, 0
    s_cmp_lg_u32 s3, 0
    s_cbranch_scc1 L_sd164
    s_mov_b32 exec_lo, 65535
    s_mov_b32 exec_hi, 0
L_sp163:
    s_add_u32 s66, s66, 1
    s_cmp_gt_u32 s66, 262144
    s_cbranch_scc1 L_sd164
    global_load_dword v89, v88, s[30:31] sc1
    s_waitcnt vmcnt(0)
    v_cmp_gt_u32 vcc, 10, v89
    s_cbranch_vccnz L_sp163
L_sd164:
    s_mov_b64 exec, -1
    s_barrier
    global_load_dwordx2 v[42:43], v40, s[30:31] sc1
    s_waitcnt lgkmcnt(0)
    s_mov_b32 s66, 0
    s_mov_b64 exec, 0x3fff
L_dq167:
    global_load_dword v14, v13, s[30:31] sc1
    s_add_u32 s66, s66, 1
    s_cmp_gt_u32 s66, 262144
    s_cbranch_scc1 L_dr168
    s_waitcnt vmcnt(0)
    v_cmp_eq_u32 vcc, 0, v14
    s_cbranch_vccnz L_dq167
L_dr168:
    s_mov_b64 exec, -1
    s_mov_b32 s66, 0
L_dp165:
    buffer_load_dwordx4 v[160:163], v57, s[52:55], s32 offen sc1
    buffer_load_dwordx4 v[164:167], v57, s[52:55], s33 offen sc1
    buffer_load_dwordx4 v[168:171], v57, s[52:55], s34 offen sc1
    buffer_load_dwordx4 v[172:175], v57, s[52:55], s35 offen sc1
    buffer_load_dwordx4 v[176:179], v57, s[52:55], s36 offen sc1
    buffer_load_dwordx4 v[180:183], v57, s[52:55], s37 offen sc1
    buffer_load_dwordx4 v[184:187], v57, s[52:55], s38 offen sc1
    s_add_u32 s66, s66, 1
    s_cmp_gt_u32 s66, 262144
    s_cbranch_scc1 L_dd166
    s_waitcnt vmcnt(6)
    v_mfma_f32_16x16x32_bf16 v[20:23], v[96:99], v[160:163], 0
    v_max3_u32 v56, v160, v161, v162
    v_mfma_f32_16x16x32_bf16 v[24:27], v[100:103], v[160:163], 0
    v_max_u32 v56, v56, v163
    s_waitcnt vmcnt(5)
    v_mfma_f32_16x16x32_bf16 v[20:23], v[104:107], v[164:167], v[20:23]
    v_max3_u32 v56, v56, v164, v165
    v_mfma_f32_16x16x32_bf16 v[24:27], v[108:111], v[164:167], v[24:27]
    v_max3_u32 v56, v56, v166, v167
    s_waitcnt vmcnt(4)
    v_mfma_f32_16x16x32_bf16 v[20:23], v[112:115], v[168:171], v[20:23]
    v_max3_u32 v56, v56, v168, v169
    v_mfma_f32_16x16x32_bf16 v[24:27], v[116:119], v[168:171], v[24:27]
    v_max3_u32 v56, v56, v170, v171
    s_waitcnt vmcnt(3)
    v_mfma_f32_16x16x32_bf16 v[20:23], v[120:123], v[172:175], v[20:23]
    v_max3_u32 v56, v56, v172, v173
    v_mfma_f32_16x16x32_bf16 v[24:27], v[124:127], v[172:175], v[24:27]
    v_max3_u32 v56, v56, v174, v175
    s_waitcnt vmcnt(2)
    v_mfma_f32_16x16x32_bf16 v[20:23], v[128:131], v[176:179], v[20:23]
    v_max3_u32 v56, v56, v176, v177
    v_mfma_f32_16x16x32_bf16 v[24:27], v[132:135], v[176:179], v[24:27]
    v_max3_u32 v56, v56, v178, v179
    s_waitcnt vmcnt(1)
    v_mfma_f32_16x16x32_bf16 v[20:23], v[136:139], v[180:183], v[20:23]
    v_max3_u32 v56, v56, v180, v181
    v_mfma_f32_16x16x32_bf16 v[24:27], v[140:143], v[180:183], v[24:27]
    v_max3_u32 v56, v56, v182, v183
    s_waitcnt vmcnt(0)
    v_mfma_f32_16x16x32_bf16 v[20:23], v[144:147], v[184:187], v[20:23]
    v_max3_u32 v56, v56, v184, v185
    v_mfma_f32_16x16x32_bf16 v[24:27], v[148:151], v[184:187], v[24:27]
    v_max3_u32 v56, v56, v186, v187
    v_cmp_eq_u32 vcc, -1, v56
    s_cbranch_vccnz L_dp165
L_dd166:
    s_waitcnt vmcnt(0)
    v_cvt_pk_bf16_f32 v42, v42, v43
    v_and_b32 v43, 0xffff0000, v42
    v_lshlrev_b32 v42, 16, v42
    s_nop 0
    v_add_f32_dpp v20, v24, v20 row_ror:8 row_mask:0xf bank_mask:0xf
    v_add_f32_dpp v21, v25, v21 row_ror:8 row_mask:0xf bank_mask:0xf
    v_add_f32_dpp v22, v26, v22 row_ror:8 row_mask:0xf bank_mask:0xf
    v_add_f32_dpp v23, v27, v23 row_ror:8 row_mask:0xf bank_mask:0xf
    ds_write_b128 v59, v[20:23] offset:16384
    s_cmp_lg_u32 s3, 0
    s_waitcnt lgkmcnt(0)
    s_barrier
    s_cbranch_scc1 L_out
    ds_read2st64_b64 v[62:65], v60 offset0:32 offset1:34
    ds_read2st64_b64 v[66:69], v60 offset0:36 offset1:38
    s_waitcnt lgkmcnt(1)
    v_pk_add_f32 v[62:63], v[62:63], v[64:65]
    s_waitcnt lgkmcnt(0)
    v_pk_add_f32 v[66:67], v[66:67], v[68:69]
    v_pk_add_f32 v[62:63], v[62:63], v[66:67]
    v_cvt_pk_bf16_f32 v62, v62, v63
    v_and_b32 v63, 0xffff0000, v62
    v_lshlrev_b32 v62, 16, v62
    v_pk_add_f32 v[62:63], v[62:63], v[42:43]
    v_cvt_pk_bf16_f32 v62, v62, v63
    global_store_dword v61, v62, s[26:27]
L_out:
L_end:
    s_endpgm
L_lead:
    s_mul_i32 s58, s2, 8192
    s_add_u32 s58, s58, 589824
    v_add_u32 v52, s58, v2
    v_mov_b32 v56, 0
    v_mov_b32 v57, 0
    v_mov_b32 v58, 0
    v_mov_b32 v59, 0
    v_add_u32 v53, 4096, v52
    s_mul_i32 s59, s2, 3456
    s_add_u32 s59, s59, 655360
    v_add_u32 v54, s59, v2
    v_mov_b32 v60, -1
    v_mov_b32 v61, -1
    v_mov_b32 v62, -1
    v_mov_b32 v63, -1
    s_waitcnt lgkmcnt(0)
    global_store_dwordx4 v52, v[56:59], s[30:31] offset:0 sc1
    global_store_dwordx4 v52, v[56:59], s[30:31] offset:1024 sc1
    global_store_dwordx4 v52, v[56:59], s[30:31] offset:2048 sc1
    global_store_dwordx4 v52, v[56:59], s[30:31] offset:3072 sc1
    global_store_dwordx4 v53, v[56:59], s[30:31] offset:0 sc1
    global_store_dwordx4 v53, v[56:59], s[30:31] offset:1024 sc1
    global_store_dwordx4 v53, v[56:59], s[30:31] offset:2048 sc1
    global_store_dwordx4 v53, v[56:59], s[30:31] offset:3072 sc1
    global_store_dwordx4 v54, v[60:63], s[30:31] offset:0 sc1
    global_store_dwordx4 v54, v[60:63], s[30:31] offset:1024 sc1
    global_store_dwordx4 v54, v[60:63], s[30:31] offset:2048 sc1
    global_store_dwordx4 v54, v[60:63], s[30:31] offset:3072 sc1
    s_branch L_k0
L_dl36:
    s_nop 7
    s_mov_b32 s57, 0
L_dx38:
    s_sleep 4
    global_load_dword v90, v88, s[28:29] sc1
    s_add_u32 s57, s57, 1
    s_waitcnt vmcnt(0)
    v_cmp_eq_u32 s[58:59], 0, v90
    s_cmp_gt_u32 s57, 262144
    s_cbranch_scc1 L_dd37
    s_cmp_lg_u32 s58, 0
    s_cbranch_scc1 L_dx38
    s_branch L_dd37
L_fs39:
    s_nop 7
    s_mov_b32 s98, 4194304
    v_add_u32 v93, s98, v93
    v_add_u32 v54, s98, v54
    s_lshl_b32 s58, s3, 4
    s_lshl_b64 exec, 0xffff, s58
    global_store_dword v93, v60, s[30:31] sc1
    s_mov_b64 exec, -1
    global_store_dword v54, v56, s[30:31] sc1
    global_store_dword v54, v57, s[30:31] offset:2048 sc1
    s_waitcnt vmcnt(0)
    s_mov_b64 exec, 1
    global_store_byte v55, v61, s[30:31] offset:128 sc1
    s_mov_b64 exec, -1
    s_branch L_fj40
L_pl66:
    s_nop 7
    s_mov_b32 s57, 0
    s_branch L_pl70
L_pl68:
    v_cmp_ne_u32 s[58:59], s66, v53
    v_cmp_ne_u32 s[68:69], 0, v53
    s_cmp_lg_u32 s98, 0
    s_cbranch_scc1 L_pl69
    s_cmp_eq_u32 s58, 0
    s_cbranch_scc1 L_pd67
    s_cmp_eq_u32 s69, 0
    s_cbranch_scc1 L_pl70
    s_mov_b32 s98, 4194304
    v_add_u32 v93, s98, v93
    v_add_u32 v54, s98, v54
    s_lshl_b32 s58, s3, 4
    s_lshl_b64 exec, 0xffff, s58
    global_store_dword v93, v60, s[30:31] sc1
    s_mov_b64 exec, -1
    global_store_dword v54, v56, s[30:31] sc1
    global_store_dword v54, v57, s[30:31] offset:2048 sc1
    s_waitcnt vmcnt(0)
    s_mov_b64 exec, 1
    global_store_byte v55, v61, s[30:31] offset:128 sc1
    s_mov_b64 exec, -1
    s_branch L_pl70
L_pl69:
    s_cmp_eq_u32 s59, 0
    s_cbranch_scc1 L_pd67
L_pl70:
    s_add_u32 s57, s57, 1
    s_cmp_gt_u32 s57, 262144
    s_cbranch_scc1 L_pd67
    s_sleep 2
    s_mov_b32 exec_hi, 0
    global_load_dword v53, v89, s[30:31] nt
    s_not_b64 exec, exec
    global_load_dword v53, v89, s[30:31] sc1
    s_mov_b64 exec, -1
    s_waitcnt vmcnt(0)
    s_branch L_pl68
L_qg71:
    s_nop 7
    global_load_dwordx4 v[56:59], v52, s[30:31] sc1
    global_load_dwordx4 v[60:63], v52, s[30:31] offset:1024 sc1
    s_branch L_qh72
L_pubs147:
    s_nop 7
    global_store_dword v93, v56, s[30:31] sc1
    s_branch L_pubq148
L_ws151:
    s_nop 7
    global_load_dwordx4 v[60:63], v43, s[30:31] sc1
    s_branch L_wt152
L_wu153:
    s_nop 7
    global_load_dwordx4 v[60:63], v43, s[30:31] sc1
    s_branch L_wv154
L_pad:
    s_endpgm
.fill 2048, 4, 0xbf810000
.section .rodata,"a"
.p2align 6
.amdhsa_kernel sequential_preLN__sliding_block_cached__glu_gated_glu__decode_kernel
  .amdhsa_next_free_vgpr 512
  .amdhsa_next_free_sgpr 102
  .amdhsa_accum_offset 256
  .amdhsa_group_segment_fixed_size 0
  .amdhsa_kernarg_size 96
  .amdhsa_user_sgpr_count 2
  .amdhsa_user_sgpr_kernarg_segment_ptr 1
  .amdhsa_system_sgpr_workgroup_id_x 1
  .amdhsa_float_denorm_mode_32 3
.end_amdhsa_kernel
```
